```python
import torch

def _softmax(x, axis=-1):
    return torch.softmax(x, dim=axis)

def _gelu(x):
    return torch.nn.functional.gelu(x, approximate='tanh')

def _silu(x):
    return torch.nn.functional.silu(x)

def _sigmoid(x):
    return torch.sigmoid(x)

def _layernorm(x, axis=-1, eps=1e-05):
    m = x.mean(dim=axis, keepdim=True)
    v = x.var(dim=axis, keepdim=True, unbiased=False)
    return (x - m) / torch.sqrt(v + eps)

def _scatter_add(tgt, idx, src, axis=0):
    return tgt.clone().index_add_(axis, idx, src)

def _segment_sum(src, seg, n):
    out = torch.zeros((n,) + src.shape[1:], dtype=src.dtype)
    return out.index_add_(0, seg, src)

def _pad(x, pw):
    flat = tuple((v for pair in reversed(pw) for v in pair))
    return torch.nn.functional.pad(x, flat)
kernel_name = 'adaLN_cond__gqa_block_cached__glu_gated_geglu__decode'

def setup_inputs():

    _w = lambda a: (lambda t: t.to(torch.bfloat16) if t.is_floating_point() else t)(torch.as_tensor(a))

    def _A_setup():
        B, Sq, D = (4, 1, 512)
        Hq, Hkv, Sk, Dh = (32, 32, 4096, 128)
        assert Hq % Hkv == 0, (Hq, Hkv)
        return {'x': _w((lambda *s: torch.randn(*s, dtype=torch.bfloat16) * 0.1)(B, Sq, D)), 'k_cache': _w((lambda *s: torch.randn(*s, dtype=torch.bfloat16) * 0.8)(B, Hkv, Sk, Dh)), 'v_cache': _w((lambda *s: torch.randn(*s, dtype=torch.bfloat16) * 3.2)(B, Hkv, Sk, Dh)), 'wq': _w((lambda *s: torch.randn(*s, dtype=torch.bfloat16) * 0.8)(D, Hq * Dh) * D ** (-0.5)), 'wo': _w((lambda *s: torch.randn(*s, dtype=torch.bfloat16) * 3.2)(Hq * Dh, D) * (Hq * Dh) ** (-0.5))}
    _A_in = _A_setup()

    def _B_setup():
        B, S, Dm, Df = (4, 1, 512, 1376)
        return {'x': _w((lambda *s: torch.randn(*s, dtype=torch.bfloat16) * 0.1)(B, S, Dm)), 'w_gate': _w((lambda *s: torch.randn(*s, dtype=torch.bfloat16) * 3.2)(Dm, Df) * Dm ** (-0.5)), 'w_up': _w((lambda *s: torch.randn(*s, dtype=torch.bfloat16) * 3.2)(Dm, Df) * Dm ** (-0.5)), 'w_down': _w((lambda *s: torch.randn(*s, dtype=torch.bfloat16) * 3.2)(Df, Dm) * Df ** (-0.5))}
    _B_in = _B_setup()
    return {'A_x': _A_in['x'], 'A_k_cache': _A_in['k_cache'], 'A_v_cache': _A_in['v_cache'], 'A_wq': _A_in['wq'], 'A_wo': _A_in['wo'], 'B_x': _B_in['x'], 'B_w_gate': _B_in['w_gate'], 'B_w_up': _B_in['w_up'], 'B_w_down': _B_in['w_down'], 'c': _w((lambda *s: torch.randn(*s, dtype=torch.bfloat16) * 0.4)(4, 512) * 8.0), 'w_mod': _w((lambda *s: torch.randn(*s, dtype=torch.bfloat16) * 0.4)(512, 6 * 512) * 512 ** (-0.5) * 8.0)}

def reference(A_x, A_k_cache, A_v_cache, A_wq, A_wo, B_x, B_w_gate, B_w_up, B_w_down, c, w_mod):

    def _A_ref(x, k_cache, v_cache, wq, wo):
        B, Sq, D = x.shape
        Hq, Dh = (32, 128)
        Hkv = k_cache.shape[1]
        rep = Hq // Hkv
        q = (lambda x, *d: x.permute(*d))((x @ wq).reshape(B, Sq, Hq, Dh), 0, 2, 1, 3)
        k = (lambda x, n, axis: torch.repeat_interleave(x, n, dim=axis))(k_cache, rep, axis=1)
        v = (lambda x, n, axis: torch.repeat_interleave(x, n, dim=axis))(v_cache, rep, axis=1)
        scores = torch.einsum('bhqd,bhkd->bhqk', q, k) * Dh ** (-0.5)
        p = _softmax(scores, axis=-1)
        o = torch.einsum('bhqk,bhkd->bhqd', p, v)
        return (lambda x, *d: x.permute(*d))(o, 0, 2, 1, 3).reshape(B, Sq, Hq * Dh) @ wo

    def _B_ref(x, w_gate, w_up, w_down):
        g = torch.einsum('bsd,df->bsf', x, w_gate)
        u = torch.einsum('bsd,df->bsf', x, w_up)
        h = _gelu(g) * u
        return torch.einsum('bsf,fd->bsd', h, w_down)
    x = A_x
    mod = (_silu(c) @ w_mod).reshape(c.shape[0], 6, 1, -1)
    sa, ca, ga, sb, cb, gb = (mod[:, 0].clone(), mod[:, 1].clone(), mod[:, 2].clone(), mod[:, 3].clone(), mod[:, 4].clone(), mod[:, 5].clone())
    h = _layernorm(x, axis=-1) * (1 + ca) + sa
    x = x + ga * _A_ref(h, A_k_cache, A_v_cache, A_wq, A_wo)
    h = _layernorm(x, axis=-1) * (1 + cb) + sb
    x = x + gb * _B_ref(h, B_w_gate, B_w_up, B_w_down)
    return x
```

```asm
; @launch grid=(256,1,1) block=(512,1,1) lds=148480
.amdgcn_target "amdgcn-amd-amdhsa--gfx950"
.text
.globl adaLN_cond__gqa_block_cached__glu_gated_geglu__decode_kernel
.p2align 8
.type adaLN_cond__gqa_block_cached__glu_gated_geglu__decode_kernel,@function
adaLN_cond__gqa_block_cached__glu_gated_geglu__decode_kernel:
  s_cmp_ge_u32 s2, 256
  s_cbranch_scc1 L_end
  s_load_dwordx16 s[16:31], s[0:1], 0
  s_load_dwordx8 s[32:39], s[0:1], 64
  s_load_dwordx4 s[40:43], s[0:1], 96
  v_lshrrev_b32 v1, 6, v0
  v_and_b32 v0, 63, v0
  s_and_b32 s10, s2, 7
  v_readfirstlane_b32 s3, v1
  s_lshr_b32 s11, s2, 3
  s_lshl_b32 s10, s10, 2
  s_lshr_b32 s12, s11, 3
  s_add_u32 s4, s10, s12
  s_bfe_u32 s5, s11, 0x20001
  s_and_b32 s6, s11, 1
  s_mov_b32 s8, 0
  s_mov_b32 s70, 0xffff0000
  s_and_b32 s9, s3, 3
  s_cmp_ge_u32 s3, 4
  s_cbranch_scc1 L_helper
  s_lshl_b32 s10, s5, 5
  s_add_u32 s100, s10, s4
  s_lshl_b32 s10, s100, 20
  s_lshl_b32 s11, s6, 19
  s_add_u32 s10, s10, s11
  s_lshl_b32 s11, s9, 10
  s_add_u32 s15, s10, s11
  s_mov_b32 s14, s15
  v_lshlrev_b32 v1, 4, v0
  s_mov_b32 s46, 134217728
  s_mov_b32 s47, 0x20000
  s_waitcnt lgkmcnt(0)
  s_mov_b32 s44, s18
  s_mov_b32 s45, s19
  s_lshr_b32 s12, s2, 5
  s_cmp_eq_u32 s12, 6
  s_cbranch_scc1 L_stream_late
  buffer_load_dwordx4 v[48:51], v1, s[44:47], s14 offen nt
  s_addk_i32 s14, 0x1000
  buffer_load_dwordx4 v[52:55], v1, s[44:47], s14 offen nt
  s_addk_i32 s14, 0x1000
  buffer_load_dwordx4 v[56:59], v1, s[44:47], s14 offen nt
  s_addk_i32 s14, 0x1000
  buffer_load_dwordx4 v[60:63], v1, s[44:47], s14 offen nt
  s_addk_i32 s14, 0x1000
  buffer_load_dwordx4 v[64:67], v1, s[44:47], s14 offen nt
  s_addk_i32 s14, 0x1000
L_stream:
  s_and_b32 s10, s2, 31
  s_lshl_b32 s10, s10, 7
  s_lshl_b32 s11, s4, 17
  s_add_u32 s11, s11, s10
  s_add_u32 s12, s10, 0x200000
  s_cmp_eq_u32 s9, 0
  s_cbranch_scc0 L_twa
  s_load_dword s26, s[24:25], s11
  s_load_dword s27, s[20:21], s15
  s_load_dword s26, s[36:37], s12
  s_load_dword s27, s[36:37], s10
  s_load_dword s26, s[28:29], s10
  s_load_dword s27, s[30:31], s10
  s_load_dword s26, s[32:33], s10
  s_load_dword s27, s[38:39], s10
L_twa:
  v_mov_b32 v2, 0
  s_mul_i32 s10, s9, 32768
  s_add_u32 m0, s10, 17408
  s_barrier
  s_waitcnt vmcnt(4)
  buffer_load_dwordx4 v[68:71], v1, s[44:47], s14 offen nt
  s_addk_i32 s14, 0x1000
  s_waitcnt vmcnt(4)
  buffer_load_dwordx4 v[72:75], v1, s[44:47], s14 offen nt
  s_addk_i32 s14, 0x1000
  s_waitcnt vmcnt(4)
  buffer_load_dwordx4 v[76:79], v1, s[44:47], s14 offen nt
  s_addk_i32 s14, 0x1000
  s_waitcnt vmcnt(4)
  buffer_load_dwordx4 v[80:83], v1, s[44:47], s14 offen nt
  s_addk_i32 s14, 0x1000
  s_waitcnt vmcnt(4)
  buffer_load_dwordx4 v[84:87], v1, s[44:47], s14 offen nt
  s_addk_i32 s14, 0x1000
  s_waitcnt vmcnt(4)
  buffer_load_dwordx4 v[88:91], v1, s[44:47], s14 offen nt
  s_addk_i32 s14, 0x1000
  s_waitcnt vmcnt(4)
  buffer_load_dwordx4 v[92:95], v1, s[44:47], s14 offen nt
  s_addk_i32 s14, 0x1000
  s_waitcnt vmcnt(4)
  buffer_load_dwordx4 v[96:99], v1, s[44:47], s14 offen nt
  s_addk_i32 s14, 0x1000
  s_waitcnt vmcnt(4)
  buffer_load_dwordx4 v[100:103], v1, s[44:47], s14 offen nt
  s_addk_i32 s14, 0x1000
  s_waitcnt vmcnt(4)
  buffer_load_dwordx4 v[104:107], v1, s[44:47], s14 offen nt
  s_addk_i32 s14, 0x1000
  s_waitcnt vmcnt(4)
  buffer_load_dwordx4 v[108:111], v1, s[44:47], s14 offen nt
  s_addk_i32 s14, 0x1000
  s_waitcnt vmcnt(4)
  buffer_load_dwordx4 v[112:115], v1, s[44:47], s14 offen nt
  s_addk_i32 s14, 0x1000
  s_waitcnt vmcnt(4)
  buffer_load_dwordx4 v[116:119], v1, s[44:47], s14 offen nt
  s_addk_i32 s14, 0x1000
  s_waitcnt vmcnt(4)
  buffer_load_dwordx4 v[120:123], v1, s[44:47], s14 offen nt
  s_addk_i32 s14, 0x1000
  s_waitcnt vmcnt(4)
  buffer_load_dwordx4 v[124:127], v1, s[44:47], s14 offen nt
  s_addk_i32 s14, 0x1000
  s_waitcnt vmcnt(4)
  buffer_load_dwordx4 v[128:131], v1, s[44:47], s14 offen nt
  s_addk_i32 s14, 0x1000
  s_waitcnt vmcnt(4)
  buffer_load_dwordx4 v[132:135], v1, s[44:47], s14 offen nt
  s_addk_i32 s14, 0x1000
  s_waitcnt vmcnt(4)
  buffer_load_dwordx4 v[136:139], v1, s[44:47], s14 offen nt
  s_addk_i32 s14, 0x1000
  s_waitcnt vmcnt(4)
  buffer_load_dwordx4 v[140:143], v1, s[44:47], s14 offen nt
  s_addk_i32 s14, 0x1000
  s_waitcnt vmcnt(4)
  buffer_load_dwordx4 v[144:147], v1, s[44:47], s14 offen nt
  s_addk_i32 s14, 0x1000
  s_waitcnt vmcnt(4)
  buffer_load_dwordx4 v[148:151], v1, s[44:47], s14 offen nt
  s_addk_i32 s14, 0x1000
  s_waitcnt vmcnt(4)
  buffer_load_dwordx4 v[152:155], v1, s[44:47], s14 offen nt
  s_addk_i32 s14, 0x1000
  s_waitcnt vmcnt(4)
  buffer_load_dwordx4 v[156:159], v1, s[44:47], s14 offen nt
  s_addk_i32 s14, 0x1000
  s_waitcnt vmcnt(4)
  buffer_load_dwordx4 v[160:163], v1, s[44:47], s14 offen nt
  s_addk_i32 s14, 0x1000
  s_waitcnt vmcnt(4)
  buffer_load_dwordx4 v[164:167], v1, s[44:47], s14 offen nt
  s_addk_i32 s14, 0x1000
  s_waitcnt vmcnt(4)
  buffer_load_dwordx4 v[168:171], v1, s[44:47], s14 offen nt
  s_addk_i32 s14, 0x1000
  s_waitcnt vmcnt(4)
  buffer_load_dwordx4 v[172:175], v1, s[44:47], s14 offen nt
  s_addk_i32 s14, 0x1000
  s_waitcnt vmcnt(4)
  buffer_load_dwordx4 v[176:179], v1, s[44:47], s14 offen nt
  s_addk_i32 s14, 0x1000
  s_waitcnt vmcnt(4)
  buffer_load_dwordx4 v[180:183], v1, s[44:47], s14 offen nt
  s_addk_i32 s14, 0x1000
  s_waitcnt vmcnt(4)
  buffer_load_dwordx4 v[184:187], v1, s[44:47], s14 offen nt
  s_addk_i32 s14, 0x1000
  s_waitcnt vmcnt(4)
  buffer_load_dwordx4 v[188:191], v1, s[44:47], s14 offen nt
  s_addk_i32 s14, 0x1000
  s_waitcnt vmcnt(4)
  buffer_load_dwordx4 v[192:195], v1, s[44:47], s14 offen nt
  s_addk_i32 s14, 0x1000
  s_waitcnt vmcnt(4)
  buffer_load_dwordx4 v[196:199], v1, s[44:47], s14 offen nt
  s_addk_i32 s14, 0x1000
  s_waitcnt vmcnt(4)
  buffer_load_dwordx4 v[200:203], v1, s[44:47], s14 offen nt
  s_addk_i32 s14, 0x1000
  s_waitcnt vmcnt(4)
  buffer_load_dwordx4 v[204:207], v1, s[44:47], s14 offen nt
  s_addk_i32 s14, 0x1000
  s_waitcnt vmcnt(4)
  buffer_load_dwordx4 v[208:211], v1, s[44:47], s14 offen nt
  s_addk_i32 s14, 0x1000
  s_waitcnt vmcnt(4)
  buffer_load_dwordx4 v[212:215], v1, s[44:47], s14 offen nt
  s_addk_i32 s14, 0x1000
  s_waitcnt vmcnt(4)
  buffer_load_dwordx4 v[216:219], v1, s[44:47], s14 offen nt
  s_addk_i32 s14, 0x1000
  s_waitcnt vmcnt(4)
  buffer_load_dwordx4 v[220:223], v1, s[44:47], s14 offen nt
  s_addk_i32 s14, 0x1000
  s_waitcnt vmcnt(4)
  buffer_load_dwordx4 v[224:227], v1, s[44:47], s14 offen nt
  s_addk_i32 s14, 0x1000
  s_waitcnt vmcnt(4)
  buffer_load_dwordx4 v[228:231], v1, s[44:47], s14 offen nt
  s_addk_i32 s14, 0x1000
  s_waitcnt vmcnt(4)
  buffer_load_dwordx4 v[232:235], v1, s[44:47], s14 offen nt
  s_addk_i32 s14, 0x1000
  s_waitcnt vmcnt(4)
  buffer_load_dwordx4 v[236:239], v1, s[44:47], s14 offen nt
  s_addk_i32 s14, 0x1000
  s_waitcnt vmcnt(4)
  buffer_load_dwordx4 v[240:243], v1, s[44:47], s14 offen nt
  s_addk_i32 s14, 0x1000
  s_waitcnt vmcnt(4)
  buffer_load_dwordx4 v[244:247], v1, s[44:47], s14 offen nt
  s_addk_i32 s14, 0x1000
  s_waitcnt vmcnt(4)
  buffer_load_dwordx4 v[248:251], v1, s[44:47], s14 offen nt
  s_addk_i32 s14, 0x1000
  s_waitcnt vmcnt(4)
  buffer_load_dwordx4 v[252:255], v1, s[44:47], s14 offen nt
  s_addk_i32 s14, 0x1000
  s_waitcnt vmcnt(4)
  buffer_load_dwordx4 v1, s[44:47], s14 offen nt lds
  s_add_u32 m0, m0, 0x400
  s_addk_i32 s14, 0x1000
  s_waitcnt vmcnt(4)
  buffer_load_dwordx4 v1, s[44:47], s14 offen nt lds
  s_add_u32 m0, m0, 0x400
  s_addk_i32 s14, 0x1000
  s_waitcnt vmcnt(4)
  buffer_load_dwordx4 v1, s[44:47], s14 offen nt lds
  s_add_u32 m0, m0, 0x400
  s_addk_i32 s14, 0x1000
  s_waitcnt vmcnt(4)
  buffer_load_dwordx4 v1, s[44:47], s14 offen nt lds
  s_add_u32 m0, m0, 0x400
  s_addk_i32 s14, 0x1000
  s_waitcnt vmcnt(4)
  buffer_load_dwordx4 v1, s[44:47], s14 offen nt lds
  s_add_u32 m0, m0, 0x400
  s_addk_i32 s14, 0x1000
  s_waitcnt vmcnt(4)
  buffer_load_dwordx4 v1, s[44:47], s14 offen nt lds
  s_add_u32 m0, m0, 0x400
  s_addk_i32 s14, 0x1000
  s_waitcnt vmcnt(4)
  buffer_load_dwordx4 v1, s[44:47], s14 offen nt lds
  s_add_u32 m0, m0, 0x400
  s_addk_i32 s14, 0x1000
  s_waitcnt vmcnt(4)
  buffer_load_dwordx4 v1, s[44:47], s14 offen nt lds
  s_add_u32 m0, m0, 0x400
  s_addk_i32 s14, 0x1000
  s_waitcnt vmcnt(4)
  buffer_load_dwordx4 v1, s[44:47], s14 offen nt lds
  s_add_u32 m0, m0, 0x400
  s_addk_i32 s14, 0x1000
  s_waitcnt vmcnt(4)
  buffer_load_dwordx4 v1, s[44:47], s14 offen nt lds
  s_add_u32 m0, m0, 0x400
  s_addk_i32 s14, 0x1000
  s_waitcnt vmcnt(4)
  buffer_load_dwordx4 v1, s[44:47], s14 offen nt lds
  s_add_u32 m0, m0, 0x400
  s_addk_i32 s14, 0x1000
  s_waitcnt vmcnt(4)
  buffer_load_dwordx4 v1, s[44:47], s14 offen nt lds
  s_add_u32 m0, m0, 0x400
  s_addk_i32 s14, 0x1000
  s_waitcnt vmcnt(4)
  buffer_load_dwordx4 v1, s[44:47], s14 offen nt lds
  s_add_u32 m0, m0, 0x400
  s_addk_i32 s14, 0x1000
  s_waitcnt vmcnt(4)
  buffer_load_dwordx4 v1, s[44:47], s14 offen nt lds
  s_add_u32 m0, m0, 0x400
  s_addk_i32 s14, 0x1000
  s_waitcnt vmcnt(4)
  buffer_load_dwordx4 v1, s[44:47], s14 offen nt lds
  s_add_u32 m0, m0, 0x400
  s_addk_i32 s14, 0x1000
  s_waitcnt vmcnt(4)
  buffer_load_dwordx4 v1, s[44:47], s14 offen nt lds
  s_add_u32 m0, m0, 0x400
  s_addk_i32 s14, 0x1000
  s_waitcnt vmcnt(4)
  buffer_load_dwordx4 v1, s[44:47], s14 offen nt lds
  s_add_u32 m0, m0, 0x400
  s_addk_i32 s14, 0x1000
  s_waitcnt vmcnt(4)
  buffer_load_dwordx4 v1, s[44:47], s14 offen nt lds
  s_add_u32 m0, m0, 0x400
  s_addk_i32 s14, 0x1000
  s_waitcnt vmcnt(4)
  buffer_load_dwordx4 v1, s[44:47], s14 offen nt lds
  s_add_u32 m0, m0, 0x400
  s_addk_i32 s14, 0x1000
  s_waitcnt vmcnt(4)
  buffer_load_dwordx4 v1, s[44:47], s14 offen nt lds
  s_add_u32 m0, m0, 0x400
  s_addk_i32 s14, 0x1000
  s_waitcnt vmcnt(4)
  buffer_load_dwordx4 v1, s[44:47], s14 offen nt lds
  s_add_u32 m0, m0, 0x400
  s_addk_i32 s14, 0x1000
  s_waitcnt vmcnt(4)
  buffer_load_dwordx4 v1, s[44:47], s14 offen nt lds
  s_add_u32 m0, m0, 0x400
  s_addk_i32 s14, 0x1000
  s_waitcnt vmcnt(4)
  buffer_load_dwordx4 v1, s[44:47], s14 offen nt lds
  s_add_u32 m0, m0, 0x400
  s_addk_i32 s14, 0x1000
  s_waitcnt vmcnt(4)
  buffer_load_dwordx4 v1, s[44:47], s14 offen nt lds
  s_add_u32 m0, m0, 0x400
  s_addk_i32 s14, 0x1000
  s_waitcnt vmcnt(4)
  buffer_load_dwordx4 v1, s[44:47], s14 offen nt lds
  s_add_u32 m0, m0, 0x400
  s_addk_i32 s14, 0x1000
  s_waitcnt vmcnt(4)
  buffer_load_dwordx4 v1, s[44:47], s14 offen nt lds
  s_add_u32 m0, m0, 0x400
  s_addk_i32 s14, 0x1000
  s_waitcnt vmcnt(4)
  buffer_load_dwordx4 v1, s[44:47], s14 offen nt lds
  s_add_u32 m0, m0, 0x400
  s_addk_i32 s14, 0x1000
  s_waitcnt vmcnt(4)
  buffer_load_dwordx4 v1, s[44:47], s14 offen nt lds
  s_add_u32 m0, m0, 0x400
  s_addk_i32 s14, 0x1000
  s_waitcnt vmcnt(4)
  buffer_load_dwordx4 v1, s[44:47], s14 offen nt lds
  s_add_u32 m0, m0, 0x400
  s_addk_i32 s14, 0x1000
  s_waitcnt vmcnt(4)
  buffer_load_dwordx4 v1, s[44:47], s14 offen nt lds
  s_add_u32 m0, m0, 0x400
  s_addk_i32 s14, 0x1000
  s_waitcnt vmcnt(4)
  buffer_load_dwordx4 v1, s[44:47], s14 offen nt lds
  s_add_u32 m0, m0, 0x400
  s_addk_i32 s14, 0x1000
  s_waitcnt vmcnt(4)
  buffer_load_dwordx4 v1, s[44:47], s14 offen nt lds
  s_addk_i32 s14, 0x1000
L_filled:
  s_mul_i32 s10, s9, 32768
  s_add_u32 s10, s10, 17408
  v_add_u32 v42, s10, v1
  s_mov_b32 s60, 0
  s_mov_b32 s61, 0x1000
  s_mov_b32 s57, 0x1000
  s_bfe_u32 s10, s2, 0x20003
  s_lshl_b32 s10, s10, 12
  s_add_u32 s68, s10, 786432
  s_lshr_b32 s10, s2, 5
  s_add_u32 s10, s10, s2
  s_and_b32 s10, s10, 3
  s_lshl_b32 s10, s10, 12
  s_add_u32 s56, s10, 786432
  s_lshl_b32 s10, s9, 28
  v_mov_b32 v45, s10
  s_lshl_b32 s10, s9, 2
  v_mov_b32 v44, s10
  s_mov_b32 s48, s20
  s_mov_b32 s49, s21
  s_mov_b32 s50, 134217728
  s_mov_b32 s51, 0x20000
  s_mov_b32 s52, s42
  s_mov_b32 s53, s43
  s_mov_b32 s54, 983040
  s_mov_b32 s55, 0x20000
  s_mov_b32 s71, 0x3fb8aa3b
  s_mov_b32 s62, 0x22222222
  s_mov_b32 s63, 0x22222222
  s_mov_b32 s64, 0x44444444
  s_mov_b32 s65, 0x44444444
  s_mov_b32 s66, 0x88888888
  s_mov_b32 s67, 0x88888888
  v_and_b32 v40, 1, v0
  v_mov_b32 v41, 0xffff
  v_lshlrev_b32 v40, 4, v40
  v_lshlrev_b32 v41, v40, v41
  v_bfe_u32 v40, v0, 1, 2
  v_cmp_eq_u32 vcc, 0, v40
  s_nop 1
  v_cndmask_b32 v4, 0, v41, vcc
  v_cmp_eq_u32 vcc, 1, v40
  s_nop 1
  v_cndmask_b32 v5, 0, v41, vcc
  v_cmp_eq_u32 vcc, 2, v40
  s_nop 1
  v_cndmask_b32 v6, 0, v41, vcc
  v_cmp_eq_u32 vcc, 3, v40
  s_nop 1
  v_cndmask_b32 v7, 0, v41, vcc
  v_and_b32 v3, 15, v0
  v_lshlrev_b32 v3, 4, v3
L_lw_9:
  ds_read_b32 v40, v2 offset:0
  s_waitcnt lgkmcnt(0)
  v_readfirstlane_b32 s10, v40
  s_cmp_ge_u32 s10, 1
  s_cbranch_scc1 L_lwd_10
  s_sleep 1
  s_add_u32 s8, s8, 1
  s_cmp_lt_u32 s8, 262144
  s_cbranch_scc1 L_lw_9
L_lwd_10:
  ds_read_b128 v[8:11], v3 offset:256
  ds_read_b32 v40, v2 offset:16
  s_waitcnt lgkmcnt(0)
  v_readfirstlane_b32 s7, v40
  v_dot2_f32_bf16 v20, v48, v8, 0
  v_dot2_f32_bf16 v21, v52, v8, 0
  v_dot2_f32_bf16 v22, v56, v8, 0
  v_dot2_f32_bf16 v23, v60, v8, 0
  v_dot2c_f32_bf16 v20, v49, v9
  v_dot2c_f32_bf16 v21, v53, v9
  v_dot2c_f32_bf16 v22, v57, v9
  v_dot2c_f32_bf16 v23, v61, v9
  v_dot2c_f32_bf16 v20, v50, v10
  v_dot2c_f32_bf16 v21, v54, v10
  v_dot2c_f32_bf16 v22, v58, v10
  v_dot2c_f32_bf16 v23, v62, v10
  v_dot2c_f32_bf16 v20, v51, v11
  v_dot2c_f32_bf16 v21, v55, v11
  v_dot2c_f32_bf16 v22, v59, v11
  v_dot2c_f32_bf16 v23, v63, v11
  v_add_f32_dpp v24, v20, v20 row_ror:8 row_mask:0xf bank_mask:0x3
  v_add_f32_dpp v24, v21, v21 row_ror:8 row_mask:0xf bank_mask:0xc
  v_add_f32_dpp v25, v22, v22 row_ror:8 row_mask:0xf bank_mask:0x3
  v_add_f32_dpp v25, v23, v23 row_ror:8 row_mask:0xf bank_mask:0xc
  v_add_f32_dpp v26, v24, v24 row_half_mirror row_mask:0xf bank_mask:0x5
  s_nop 0
  v_add_f32_dpp v26, v25, v25 row_half_mirror row_mask:0xf bank_mask:0xa
  s_nop 1
  v_add_f32_dpp v26, v26, v26 quad_perm:[1,0,3,2] row_mask:0xf bank_mask:0xf
  s_nop 1
  v_add_f32_dpp v12, v26, v26 quad_perm:[2,3,0,1] row_mask:0xf bank_mask:0xf
  s_waitcnt vmcnt(4)
  buffer_load_dwordx4 v[48:51], v1, s[44:47], s14 offen nt
  v_add_u32 v1, s61, v1
  v_mov_b32 v47, 1
  s_mov_b64 exec, 1
  buffer_atomic_add v47, v45, s[52:55], s68 offen offset:0 sc0
  s_mov_b64 exec, -1
  v_dot2_f32_bf16 v20, v64, v8, 0
  v_dot2_f32_bf16 v21, v68, v8, 0
  v_dot2_f32_bf16 v22, v72, v8, 0
  v_dot2_f32_bf16 v23, v76, v8, 0
  v_dot2c_f32_bf16 v20, v65, v9
  v_dot2c_f32_bf16 v21, v69, v9
  v_dot2c_f32_bf16 v22, v73, v9
  v_dot2c_f32_bf16 v23, v77, v9
  v_dot2c_f32_bf16 v20, v66, v10
  v_dot2c_f32_bf16 v21, v70, v10
  v_dot2c_f32_bf16 v22, v74, v10
  v_dot2c_f32_bf16 v23, v78, v10
  v_dot2c_f32_bf16 v20, v67, v11
  v_dot2c_f32_bf16 v21, v71, v11
  v_dot2c_f32_bf16 v22, v75, v11
  v_dot2c_f32_bf16 v23, v79, v11
  v_add_f32_dpp v24, v20, v20 row_ror:8 row_mask:0xf bank_mask:0x3
  v_add_f32_dpp v24, v21, v21 row_ror:8 row_mask:0xf bank_mask:0xc
  v_add_f32_dpp v25, v22, v22 row_ror:8 row_mask:0xf bank_mask:0x3
  v_add_f32_dpp v25, v23, v23 row_ror:8 row_mask:0xf bank_mask:0xc
  v_add_f32_dpp v26, v24, v24 row_half_mirror row_mask:0xf bank_mask:0x5
  s_nop 0
  v_add_f32_dpp v26, v25, v25 row_half_mirror row_mask:0xf bank_mask:0xa
  s_nop 1
  v_add_f32_dpp v26, v26, v26 quad_perm:[1,0,3,2] row_mask:0xf bank_mask:0xf
  s_nop 1
  v_add_f32_dpp v27, v26, v26 quad_perm:[2,3,0,1] row_mask:0xf bank_mask:0xf
  v_cndmask_b32 v12, v12, v27, s[62:63]
  s_cmp_ge_i32 s60, 40
  s_cselect_b64 vcc, -1, 0
  s_cmp_ge_i32 s60, -40
  s_cbranch_scc1 L_a_11
  s_waitcnt vmcnt(4)
L_a_11:
  s_cbranch_vccnz L_b_12
  s_waitcnt vmcnt(5)
L_b_12:
  buffer_load_dwordx4 v[52:55], v1, s[44:47], s14 offen nt
  v_add_u32 v1, s61, v1
  v_dot2_f32_bf16 v20, v80, v8, 0
  v_dot2_f32_bf16 v21, v84, v8, 0
  v_dot2_f32_bf16 v22, v88, v8, 0
  v_dot2_f32_bf16 v23, v92, v8, 0
  v_dot2c_f32_bf16 v20, v81, v9
  v_dot2c_f32_bf16 v21, v85, v9
  v_dot2c_f32_bf16 v22, v89, v9
  v_dot2c_f32_bf16 v23, v93, v9
  v_dot2c_f32_bf16 v20, v82, v10
  v_dot2c_f32_bf16 v21, v86, v10
  v_dot2c_f32_bf16 v22, v90, v10
  v_dot2c_f32_bf16 v23, v94, v10
  v_dot2c_f32_bf16 v20, v83, v11
  v_dot2c_f32_bf16 v21, v87, v11
  v_dot2c_f32_bf16 v22, v91, v11
  v_dot2c_f32_bf16 v23, v95, v11
  v_add_f32_dpp v24, v20, v20 row_ror:8 row_mask:0xf bank_mask:0x3
  v_add_f32_dpp v24, v21, v21 row_ror:8 row_mask:0xf bank_mask:0xc
  v_add_f32_dpp v25, v22, v22 row_ror:8 row_mask:0xf bank_mask:0x3
  v_add_f32_dpp v25, v23, v23 row_ror:8 row_mask:0xf bank_mask:0xc
  v_add_f32_dpp v26, v24, v24 row_half_mirror row_mask:0xf bank_mask:0x5
  s_nop 0
  v_add_f32_dpp v26, v25, v25 row_half_mirror row_mask:0xf bank_mask:0xa
  s_nop 1
  v_add_f32_dpp v26, v26, v26 quad_perm:[1,0,3,2] row_mask:0xf bank_mask:0xf
  s_nop 1
  v_add_f32_dpp v27, v26, v26 quad_perm:[2,3,0,1] row_mask:0xf bank_mask:0xf
  v_cndmask_b32 v12, v12, v27, s[64:65]
  s_cbranch_scc1 L_a_13
  s_waitcnt vmcnt(4)
L_a_13:
  s_cbranch_vccnz L_b_14
  s_waitcnt vmcnt(5)
L_b_14:
  buffer_load_dwordx4 v[56:59], v1, s[44:47], s14 offen nt
  v_add_u32 v1, s61, v1
  v_dot2_f32_bf16 v20, v96, v8, 0
  v_dot2_f32_bf16 v21, v100, v8, 0
  v_dot2_f32_bf16 v22, v104, v8, 0
  v_dot2_f32_bf16 v23, v108, v8, 0
  v_dot2c_f32_bf16 v20, v97, v9
  v_dot2c_f32_bf16 v21, v101, v9
  v_dot2c_f32_bf16 v22, v105, v9
  v_dot2c_f32_bf16 v23, v109, v9
  v_dot2c_f32_bf16 v20, v98, v10
  v_dot2c_f32_bf16 v21, v102, v10
  v_dot2c_f32_bf16 v22, v106, v10
  v_dot2c_f32_bf16 v23, v110, v10
  v_dot2c_f32_bf16 v20, v99, v11
  v_dot2c_f32_bf16 v21, v103, v11
  v_dot2c_f32_bf16 v22, v107, v11
  v_dot2c_f32_bf16 v23, v111, v11
  v_add_f32_dpp v24, v20, v20 row_ror:8 row_mask:0xf bank_mask:0x3
  v_add_f32_dpp v24, v21, v21 row_ror:8 row_mask:0xf bank_mask:0xc
  v_add_f32_dpp v25, v22, v22 row_ror:8 row_mask:0xf bank_mask:0x3
  v_add_f32_dpp v25, v23, v23 row_ror:8 row_mask:0xf bank_mask:0xc
  v_add_f32_dpp v26, v24, v24 row_half_mirror row_mask:0xf bank_mask:0x5
  s_nop 0
  v_add_f32_dpp v26, v25, v25 row_half_mirror row_mask:0xf bank_mask:0xa
  s_nop 1
  v_add_f32_dpp v26, v26, v26 quad_perm:[1,0,3,2] row_mask:0xf bank_mask:0xf
  s_nop 1
  v_add_f32_dpp v27, v26, v26 quad_perm:[2,3,0,1] row_mask:0xf bank_mask:0xf
  v_cndmask_b32 v12, v12, v27, s[66:67]
  s_cbranch_scc1 L_a_15
  s_waitcnt vmcnt(4)
L_a_15:
  s_cbranch_vccnz L_b_16
  s_waitcnt vmcnt(5)
L_b_16:
  s_waitcnt vmcnt(7)
  buffer_load_dwordx4 v[60:63], v1, s[44:47], s14 offen nt
  v_add_u32 v1, s61, v1
  v_dot2_f32_bf16 v20, v112, v8, 0
  v_dot2_f32_bf16 v21, v116, v8, 0
  v_dot2_f32_bf16 v22, v120, v8, 0
  v_dot2_f32_bf16 v23, v124, v8, 0
  v_dot2c_f32_bf16 v20, v113, v9
  v_dot2c_f32_bf16 v21, v117, v9
  v_dot2c_f32_bf16 v22, v121, v9
  v_dot2c_f32_bf16 v23, v125, v9
  v_dot2c_f32_bf16 v20, v114, v10
  v_dot2c_f32_bf16 v21, v118, v10
  v_dot2c_f32_bf16 v22, v122, v10
  v_dot2c_f32_bf16 v23, v126, v10
  v_dot2c_f32_bf16 v20, v115, v11
  v_dot2c_f32_bf16 v21, v119, v11
  v_dot2c_f32_bf16 v22, v123, v11
  v_dot2c_f32_bf16 v23, v127, v11
  v_add_f32_dpp v24, v20, v20 row_ror:8 row_mask:0xf bank_mask:0x3
  v_add_f32_dpp v24, v21, v21 row_ror:8 row_mask:0xf bank_mask:0xc
  v_add_f32_dpp v25, v22, v22 row_ror:8 row_mask:0xf bank_mask:0x3
  v_add_f32_dpp v25, v23, v23 row_ror:8 row_mask:0xf bank_mask:0xc
  v_add_f32_dpp v26, v24, v24 row_half_mirror row_mask:0xf bank_mask:0x5
  s_nop 0
  v_add_f32_dpp v26, v25, v25 row_half_mirror row_mask:0xf bank_mask:0xa
  s_nop 1
  v_add_f32_dpp v26, v26, v26 quad_perm:[1,0,3,2] row_mask:0xf bank_mask:0xf
  s_nop 1
  v_add_f32_dpp v13, v26, v26 quad_perm:[2,3,0,1] row_mask:0xf bank_mask:0xf
  s_cbranch_scc1 L_a_17
  s_waitcnt vmcnt(4)
L_a_17:
  s_cbranch_vccnz L_b_18
  s_waitcnt vmcnt(5)
L_b_18:
  s_waitcnt vmcnt(7)
  buffer_load_dwordx4 v[64:67], v1, s[44:47], s14 offen nt
  v_add_u32 v1, s61, v1
  v_dot2_f32_bf16 v20, v128, v8, 0
  v_dot2_f32_bf16 v21, v132, v8, 0
  v_dot2_f32_bf16 v22, v136, v8, 0
  v_dot2_f32_bf16 v23, v140, v8, 0
  v_dot2c_f32_bf16 v20, v129, v9
  v_dot2c_f32_bf16 v21, v133, v9
  v_dot2c_f32_bf16 v22, v137, v9
  v_dot2c_f32_bf16 v23, v141, v9
  v_dot2c_f32_bf16 v20, v130, v10
  v_dot2c_f32_bf16 v21, v134, v10
  v_dot2c_f32_bf16 v22, v138, v10
  v_dot2c_f32_bf16 v23, v142, v10
  v_dot2c_f32_bf16 v20, v131, v11
  v_dot2c_f32_bf16 v21, v135, v11
  v_dot2c_f32_bf16 v22, v139, v11
  v_dot2c_f32_bf16 v23, v143, v11
  v_add_f32_dpp v24, v20, v20 row_ror:8 row_mask:0xf bank_mask:0x3
  v_add_f32_dpp v24, v21, v21 row_ror:8 row_mask:0xf bank_mask:0xc
  v_add_f32_dpp v25, v22, v22 row_ror:8 row_mask:0xf bank_mask:0x3
  v_add_f32_dpp v25, v23, v23 row_ror:8 row_mask:0xf bank_mask:0xc
  v_add_f32_dpp v26, v24, v24 row_half_mirror row_mask:0xf bank_mask:0x5
  s_nop 0
  v_add_f32_dpp v26, v25, v25 row_half_mirror row_mask:0xf bank_mask:0xa
  s_nop 1
  v_add_f32_dpp v26, v26, v26 quad_perm:[1,0,3,2] row_mask:0xf bank_mask:0xf
  s_nop 1
  v_add_f32_dpp v27, v26, v26 quad_perm:[2,3,0,1] row_mask:0xf bank_mask:0xf
  v_cndmask_b32 v13, v13, v27, s[62:63]
  s_cbranch_scc1 L_a_19
  s_waitcnt vmcnt(3)
L_a_19:
  s_cbranch_vccnz L_b_20
  s_waitcnt vmcnt(5)
L_b_20:
  s_waitcnt vmcnt(7)
  buffer_load_dwordx4 v[68:71], v1, s[44:47], s14 offen nt
  v_add_u32 v1, s61, v1
  v_dot2_f32_bf16 v20, v144, v8, 0
  v_dot2_f32_bf16 v21, v148, v8, 0
  v_dot2_f32_bf16 v22, v152, v8, 0
  v_dot2_f32_bf16 v23, v156, v8, 0
  v_dot2c_f32_bf16 v20, v145, v9
  v_dot2c_f32_bf16 v21, v149, v9
  v_dot2c_f32_bf16 v22, v153, v9
  v_dot2c_f32_bf16 v23, v157, v9
  v_dot2c_f32_bf16 v20, v146, v10
  v_dot2c_f32_bf16 v21, v150, v10
  v_dot2c_f32_bf16 v22, v154, v10
  v_dot2c_f32_bf16 v23, v158, v10
  v_dot2c_f32_bf16 v20, v147, v11
  v_dot2c_f32_bf16 v21, v151, v11
  v_dot2c_f32_bf16 v22, v155, v11
  v_dot2c_f32_bf16 v23, v159, v11
  v_add_f32_dpp v24, v20, v20 row_ror:8 row_mask:0xf bank_mask:0x3
  v_add_f32_dpp v24, v21, v21 row_ror:8 row_mask:0xf bank_mask:0xc
  v_add_f32_dpp v25, v22, v22 row_ror:8 row_mask:0xf bank_mask:0x3
  v_add_f32_dpp v25, v23, v23 row_ror:8 row_mask:0xf bank_mask:0xc
  v_add_f32_dpp v26, v24, v24 row_half_mirror row_mask:0xf bank_mask:0x5
  s_nop 0
  v_add_f32_dpp v26, v25, v25 row_half_mirror row_mask:0xf bank_mask:0xa
  s_nop 1
  v_add_f32_dpp v26, v26, v26 quad_perm:[1,0,3,2] row_mask:0xf bank_mask:0xf
  s_nop 1
  v_add_f32_dpp v27, v26, v26 quad_perm:[2,3,0,1] row_mask:0xf bank_mask:0xf
  v_cndmask_b32 v13, v13, v27, s[64:65]
  s_cbranch_scc1 L_a_21
  s_waitcnt vmcnt(3)
L_a_21:
  s_cbranch_vccnz L_b_22
  s_waitcnt vmcnt(4)
L_b_22:
  s_waitcnt vmcnt(7)
  buffer_load_dwordx4 v[72:75], v1, s[44:47], s14 offen nt
  v_add_u32 v1, s61, v1
  v_dot2_f32_bf16 v20, v160, v8, 0
  v_dot2_f32_bf16 v21, v164, v8, 0
  v_dot2_f32_bf16 v22, v168, v8, 0
  v_dot2_f32_bf16 v23, v172, v8, 0
  v_dot2c_f32_bf16 v20, v161, v9
  v_dot2c_f32_bf16 v21, v165, v9
  v_dot2c_f32_bf16 v22, v169, v9
  v_dot2c_f32_bf16 v23, v173, v9
  v_dot2c_f32_bf16 v20, v162, v10
  v_dot2c_f32_bf16 v21, v166, v10
  v_dot2c_f32_bf16 v22, v170, v10
  v_dot2c_f32_bf16 v23, v174, v10
  v_dot2c_f32_bf16 v20, v163, v11
  v_dot2c_f32_bf16 v21, v167, v11
  v_dot2c_f32_bf16 v22, v171, v11
  v_dot2c_f32_bf16 v23, v175, v11
  v_add_f32_dpp v24, v20, v20 row_ror:8 row_mask:0xf bank_mask:0x3
  v_add_f32_dpp v24, v21, v21 row_ror:8 row_mask:0xf bank_mask:0xc
  v_add_f32_dpp v25, v22, v22 row_ror:8 row_mask:0xf bank_mask:0x3
  v_add_f32_dpp v25, v23, v23 row_ror:8 row_mask:0xf bank_mask:0xc
  v_add_f32_dpp v26, v24, v24 row_half_mirror row_mask:0xf bank_mask:0x5
  s_nop 0
  v_add_f32_dpp v26, v25, v25 row_half_mirror row_mask:0xf bank_mask:0xa
  s_nop 1
  v_add_f32_dpp v26, v26, v26 quad_perm:[1,0,3,2] row_mask:0xf bank_mask:0xf
  s_nop 1
  v_add_f32_dpp v27, v26, v26 quad_perm:[2,3,0,1] row_mask:0xf bank_mask:0xf
  v_cndmask_b32 v13, v13, v27, s[66:67]
  s_cbranch_scc1 L_a_23
  s_waitcnt vmcnt(3)
L_a_23:
  s_cbranch_vccnz L_b_24
  s_waitcnt vmcnt(4)
L_b_24:
  s_waitcnt vmcnt(7)
  buffer_load_dwordx4 v[76:79], v1, s[44:47], s14 offen nt
  v_add_u32 v1, s61, v1
  v_dot2_f32_bf16 v20, v176, v8, 0
  v_dot2_f32_bf16 v21, v180, v8, 0
  v_dot2_f32_bf16 v22, v184, v8, 0
  v_dot2_f32_bf16 v23, v188, v8, 0
  v_dot2c_f32_bf16 v20, v177, v9
  v_dot2c_f32_bf16 v21, v181, v9
  v_dot2c_f32_bf16 v22, v185, v9
  v_dot2c_f32_bf16 v23, v189, v9
  v_dot2c_f32_bf16 v20, v178, v10
  v_dot2c_f32_bf16 v21, v182, v10
  v_dot2c_f32_bf16 v22, v186, v10
  v_dot2c_f32_bf16 v23, v190, v10
  v_dot2c_f32_bf16 v20, v179, v11
  v_dot2c_f32_bf16 v21, v183, v11
  v_dot2c_f32_bf16 v22, v187, v11
  v_dot2c_f32_bf16 v23, v191, v11
  v_add_f32_dpp v24, v20, v20 row_ror:8 row_mask:0xf bank_mask:0x3
  v_add_f32_dpp v24, v21, v21 row_ror:8 row_mask:0xf bank_mask:0xc
  v_add_f32_dpp v25, v22, v22 row_ror:8 row_mask:0xf bank_mask:0x3
  v_add_f32_dpp v25, v23, v23 row_ror:8 row_mask:0xf bank_mask:0xc
  v_add_f32_dpp v26, v24, v24 row_half_mirror row_mask:0xf bank_mask:0x5
  s_nop 0
  v_add_f32_dpp v26, v25, v25 row_half_mirror row_mask:0xf bank_mask:0xa
  s_nop 1
  v_add_f32_dpp v26, v26, v26 quad_perm:[1,0,3,2] row_mask:0xf bank_mask:0xf
  s_nop 1
  v_add_f32_dpp v14, v26, v26 quad_perm:[2,3,0,1] row_mask:0xf bank_mask:0xf
  s_cbranch_scc1 L_a_25
  s_waitcnt vmcnt(3)
L_a_25:
  s_cbranch_vccnz L_b_26
  s_waitcnt vmcnt(4)
L_b_26:
  s_waitcnt vmcnt(6)
  buffer_load_dwordx4 v[80:83], v1, s[44:47], s14 offen nt
  v_add_u32 v1, s61, v1
  v_subrev_u32 v47, 32, v47
  s_mov_b64 exec, 1
  ds_write_b32 v44, v47 offset:20
  s_mov_b64 exec, -1
  v_dot2_f32_bf16 v20, v192, v8, 0
  v_dot2_f32_bf16 v21, v196, v8, 0
  v_dot2_f32_bf16 v22, v200, v8, 0
  v_dot2_f32_bf16 v23, v204, v8, 0
  v_dot2c_f32_bf16 v20, v193, v9
  v_dot2c_f32_bf16 v21, v197, v9
  v_dot2c_f32_bf16 v22, v201, v9
  v_dot2c_f32_bf16 v23, v205, v9
  v_dot2c_f32_bf16 v20, v194, v10
  v_dot2c_f32_bf16 v21, v198, v10
  v_dot2c_f32_bf16 v22, v202, v10
  v_dot2c_f32_bf16 v23, v206, v10
  v_dot2c_f32_bf16 v20, v195, v11
  v_dot2c_f32_bf16 v21, v199, v11
  v_dot2c_f32_bf16 v22, v203, v11
  v_dot2c_f32_bf16 v23, v207, v11
  v_add_f32_dpp v24, v20, v20 row_ror:8 row_mask:0xf bank_mask:0x3
  v_add_f32_dpp v24, v21, v21 row_ror:8 row_mask:0xf bank_mask:0xc
  v_add_f32_dpp v25, v22, v22 row_ror:8 row_mask:0xf bank_mask:0x3
  v_add_f32_dpp v25, v23, v23 row_ror:8 row_mask:0xf bank_mask:0xc
  v_add_f32_dpp v26, v24, v24 row_half_mirror row_mask:0xf bank_mask:0x5
  s_nop 0
  v_add_f32_dpp v26, v25, v25 row_half_mirror row_mask:0xf bank_mask:0xa
  s_nop 1
  v_add_f32_dpp v26, v26, v26 quad_perm:[1,0,3,2] row_mask:0xf bank_mask:0xf
  s_nop 1
  v_add_f32_dpp v27, v26, v26 quad_perm:[2,3,0,1] row_mask:0xf bank_mask:0xf
  v_cndmask_b32 v14, v14, v27, s[62:63]
  s_cbranch_scc1 L_a_27
  s_waitcnt vmcnt(3)
L_a_27:
  s_cbranch_vccnz L_b_28
  s_waitcnt vmcnt(4)
L_b_28:
  s_waitcnt vmcnt(6)
  buffer_load_dwordx4 v[84:87], v1, s[44:47], s14 offen nt
  v_add_u32 v1, s61, v1
  ds_read_b32 v46, v2 offset:20
  v_dot2_f32_bf16 v20, v208, v8, 0
  v_dot2_f32_bf16 v21, v212, v8, 0
  v_dot2_f32_bf16 v22, v216, v8, 0
  v_dot2_f32_bf16 v23, v220, v8, 0
  v_dot2c_f32_bf16 v20, v209, v9
  v_dot2c_f32_bf16 v21, v213, v9
  v_dot2c_f32_bf16 v22, v217, v9
  v_dot2c_f32_bf16 v23, v221, v9
  v_dot2c_f32_bf16 v20, v210, v10
  v_dot2c_f32_bf16 v21, v214, v10
  v_dot2c_f32_bf16 v22, v218, v10
  v_dot2c_f32_bf16 v23, v222, v10
  v_dot2c_f32_bf16 v20, v211, v11
  v_dot2c_f32_bf16 v21, v215, v11
  v_dot2c_f32_bf16 v22, v219, v11
  v_dot2c_f32_bf16 v23, v223, v11
  v_add_f32_dpp v24, v20, v20 row_ror:8 row_mask:0xf bank_mask:0x3
  v_add_f32_dpp v24, v21, v21 row_ror:8 row_mask:0xf bank_mask:0xc
  v_add_f32_dpp v25, v22, v22 row_ror:8 row_mask:0xf bank_mask:0x3
  v_add_f32_dpp v25, v23, v23 row_ror:8 row_mask:0xf bank_mask:0xc
  v_add_f32_dpp v26, v24, v24 row_half_mirror row_mask:0xf bank_mask:0x5
  s_nop 0
  v_add_f32_dpp v26, v25, v25 row_half_mirror row_mask:0xf bank_mask:0xa
  s_nop 1
  v_add_f32_dpp v26, v26, v26 quad_perm:[1,0,3,2] row_mask:0xf bank_mask:0xf
  s_nop 1
  v_add_f32_dpp v27, v26, v26 quad_perm:[2,3,0,1] row_mask:0xf bank_mask:0xf
  v_cndmask_b32 v14, v14, v27, s[64:65]
  s_waitcnt lgkmcnt(0)
  v_readfirstlane_b32 s60, v46
  s_cmp_ge_i32 s60, 5
  s_cselect_b64 vcc, -1, 0
  s_cmp_ge_i32 s60, -5
  s_cbranch_scc1 L_a_29
  s_waitcnt vmcnt(3)
L_a_29:
  s_cbranch_vccnz L_b_30
  s_waitcnt vmcnt(4)
L_b_30:
  s_waitcnt vmcnt(6)
  buffer_load_dwordx4 v[88:91], v1, s[44:47], s14 offen nt
  v_add_u32 v1, s61, v1
  v_dot2_f32_bf16 v20, v224, v8, 0
  v_dot2_f32_bf16 v21, v228, v8, 0
  v_dot2_f32_bf16 v22, v232, v8, 0
  v_dot2_f32_bf16 v23, v236, v8, 0
  v_dot2c_f32_bf16 v20, v225, v9
  v_dot2c_f32_bf16 v21, v229, v9
  v_dot2c_f32_bf16 v22, v233, v9
  v_dot2c_f32_bf16 v23, v237, v9
  v_dot2c_f32_bf16 v20, v226, v10
  v_dot2c_f32_bf16 v21, v230, v10
  v_dot2c_f32_bf16 v22, v234, v10
  v_dot2c_f32_bf16 v23, v238, v10
  v_dot2c_f32_bf16 v20, v227, v11
  v_dot2c_f32_bf16 v21, v231, v11
  v_dot2c_f32_bf16 v22, v235, v11
  v_dot2c_f32_bf16 v23, v239, v11
  v_add_f32_dpp v24, v20, v20 row_ror:8 row_mask:0xf bank_mask:0x3
  v_add_f32_dpp v24, v21, v21 row_ror:8 row_mask:0xf bank_mask:0xc
  v_add_f32_dpp v25, v22, v22 row_ror:8 row_mask:0xf bank_mask:0x3
  v_add_f32_dpp v25, v23, v23 row_ror:8 row_mask:0xf bank_mask:0xc
  v_add_f32_dpp v26, v24, v24 row_half_mirror row_mask:0xf bank_mask:0x5
  s_nop 0
  v_add_f32_dpp v26, v25, v25 row_half_mirror row_mask:0xf bank_mask:0xa
  s_nop 1
  v_add_f32_dpp v26, v26, v26 quad_perm:[1,0,3,2] row_mask:0xf bank_mask:0xf
  s_nop 1
  v_add_f32_dpp v27, v26, v26 quad_perm:[2,3,0,1] row_mask:0xf bank_mask:0xf
  v_cndmask_b32 v14, v14, v27, s[66:67]
  s_cbranch_scc1 L_a_31
  s_waitcnt vmcnt(3)
L_a_31:
  s_cbranch_vccnz L_b_32
  s_waitcnt vmcnt(4)
L_b_32:
  s_waitcnt vmcnt(6)
  buffer_load_dwordx4 v[92:95], v1, s[44:47], s14 offen nt
  v_add_u32 v1, s61, v1
  v_dot2_f32_bf16 v20, v240, v8, 0
  v_dot2_f32_bf16 v21, v244, v8, 0
  v_dot2_f32_bf16 v22, v248, v8, 0
  v_dot2_f32_bf16 v23, v252, v8, 0
  v_dot2c_f32_bf16 v20, v241, v9
  v_dot2c_f32_bf16 v21, v245, v9
  v_dot2c_f32_bf16 v22, v249, v9
  v_dot2c_f32_bf16 v23, v253, v9
  v_dot2c_f32_bf16 v20, v242, v10
  v_dot2c_f32_bf16 v21, v246, v10
  v_dot2c_f32_bf16 v22, v250, v10
  v_dot2c_f32_bf16 v23, v254, v10
  v_dot2c_f32_bf16 v20, v243, v11
  v_dot2c_f32_bf16 v21, v247, v11
  v_dot2c_f32_bf16 v22, v251, v11
  v_dot2c_f32_bf16 v23, v255, v11
  v_add_f32_dpp v24, v20, v20 row_ror:8 row_mask:0xf bank_mask:0x3
  v_add_f32_dpp v24, v21, v21 row_ror:8 row_mask:0xf bank_mask:0xc
  v_add_f32_dpp v25, v22, v22 row_ror:8 row_mask:0xf bank_mask:0x3
  v_add_f32_dpp v25, v23, v23 row_ror:8 row_mask:0xf bank_mask:0xc
  v_add_f32_dpp v26, v24, v24 row_half_mirror row_mask:0xf bank_mask:0x5
  s_nop 0
  v_add_f32_dpp v26, v25, v25 row_half_mirror row_mask:0xf bank_mask:0xa
  s_nop 1
  v_add_f32_dpp v26, v26, v26 quad_perm:[1,0,3,2] row_mask:0xf bank_mask:0xf
  s_nop 1
  v_add_f32_dpp v15, v26, v26 quad_perm:[2,3,0,1] row_mask:0xf bank_mask:0xf
  s_cbranch_scc1 L_a_33
  s_waitcnt vmcnt(3)
L_a_33:
  s_cbranch_vccnz L_b_34
  s_waitcnt vmcnt(4)
L_b_34:
  s_waitcnt vmcnt(6)
  buffer_load_dwordx4 v[96:99], v1, s[44:47], s14 offen nt
  v_add_u32 v1, s61, v1
  ds_read_b32 v46, v2 offset:20
  ds_read_b128 v[100:103], v42 offset:0
  ds_read_b128 v[104:107], v42 offset:1024
  ds_read_b128 v[108:111], v42 offset:2048
  ds_read_b128 v[112:115], v42 offset:3072
  ds_read_b128 v[116:119], v42 offset:4096
  ds_read_b128 v[120:123], v42 offset:5120
  ds_read_b128 v[124:127], v42 offset:6144
  ds_read_b128 v[128:131], v42 offset:7168
  s_waitcnt lgkmcnt(4)
  v_dot2_f32_bf16 v20, v100, v8, 0
  v_dot2_f32_bf16 v21, v104, v8, 0
  v_dot2_f32_bf16 v22, v108, v8, 0
  v_dot2_f32_bf16 v23, v112, v8, 0
  v_dot2c_f32_bf16 v20, v101, v9
  v_dot2c_f32_bf16 v21, v105, v9
  v_dot2c_f32_bf16 v22, v109, v9
  v_dot2c_f32_bf16 v23, v113, v9
  v_dot2c_f32_bf16 v20, v102, v10
  v_dot2c_f32_bf16 v21, v106, v10
  v_dot2c_f32_bf16 v22, v110, v10
  v_dot2c_f32_bf16 v23, v114, v10
  v_dot2c_f32_bf16 v20, v103, v11
  v_dot2c_f32_bf16 v21, v107, v11
  v_dot2c_f32_bf16 v22, v111, v11
  v_dot2c_f32_bf16 v23, v115, v11
  v_add_f32_dpp v24, v20, v20 row_ror:8 row_mask:0xf bank_mask:0x3
  v_add_f32_dpp v24, v21, v21 row_ror:8 row_mask:0xf bank_mask:0xc
  v_add_f32_dpp v25, v22, v22 row_ror:8 row_mask:0xf bank_mask:0x3
  v_add_f32_dpp v25, v23, v23 row_ror:8 row_mask:0xf bank_mask:0xc
  v_add_f32_dpp v26, v24, v24 row_half_mirror row_mask:0xf bank_mask:0x5
  s_nop 0
  v_add_f32_dpp v26, v25, v25 row_half_mirror row_mask:0xf bank_mask:0xa
  s_nop 1
  v_add_f32_dpp v26, v26, v26 quad_perm:[1,0,3,2] row_mask:0xf bank_mask:0xf
  s_nop 1
  v_add_f32_dpp v27, v26, v26 quad_perm:[2,3,0,1] row_mask:0xf bank_mask:0xf
  v_cndmask_b32 v15, v15, v27, s[62:63]
  s_waitcnt lgkmcnt(0)
  v_readfirstlane_b32 s60, v46
  s_cmp_ge_i32 s60, 5
  s_cselect_b64 vcc, -1, 0
  s_cmp_ge_i32 s60, -5
  s_cbranch_scc1 L_a_35
  s_waitcnt vmcnt(3)
L_a_35:
  s_cbranch_vccnz L_b_36
  s_waitcnt vmcnt(4)
L_b_36:
  s_waitcnt vmcnt(6)
  buffer_load_dwordx4 v[132:135], v1, s[44:47], s14 offen nt
  v_add_u32 v1, s61, v1
  ds_read_b128 v[136:139], v42 offset:8192
  ds_read_b128 v[140:143], v42 offset:9216
  ds_read_b128 v[144:147], v42 offset:10240
  ds_read_b128 v[148:151], v42 offset:11264
  s_waitcnt lgkmcnt(4)
  v_dot2_f32_bf16 v20, v116, v8, 0
  v_dot2_f32_bf16 v21, v120, v8, 0
  v_dot2_f32_bf16 v22, v124, v8, 0
  v_dot2_f32_bf16 v23, v128, v8, 0
  v_dot2c_f32_bf16 v20, v117, v9
  v_dot2c_f32_bf16 v21, v121, v9
  v_dot2c_f32_bf16 v22, v125, v9
  v_dot2c_f32_bf16 v23, v129, v9
  v_dot2c_f32_bf16 v20, v118, v10
  v_dot2c_f32_bf16 v21, v122, v10
  v_dot2c_f32_bf16 v22, v126, v10
  v_dot2c_f32_bf16 v23, v130, v10
  v_dot2c_f32_bf16 v20, v119, v11
  v_dot2c_f32_bf16 v21, v123, v11
  v_dot2c_f32_bf16 v22, v127, v11
  v_dot2c_f32_bf16 v23, v131, v11
  v_add_f32_dpp v24, v20, v20 row_ror:8 row_mask:0xf bank_mask:0x3
  v_add_f32_dpp v24, v21, v21 row_ror:8 row_mask:0xf bank_mask:0xc
  v_add_f32_dpp v25, v22, v22 row_ror:8 row_mask:0xf bank_mask:0x3
  v_add_f32_dpp v25, v23, v23 row_ror:8 row_mask:0xf bank_mask:0xc
  v_add_f32_dpp v26, v24, v24 row_half_mirror row_mask:0xf bank_mask:0x5
  s_nop 0
  v_add_f32_dpp v26, v25, v25 row_half_mirror row_mask:0xf bank_mask:0xa
  s_nop 1
  v_add_f32_dpp v26, v26, v26 quad_perm:[1,0,3,2] row_mask:0xf bank_mask:0xf
  s_nop 1
  v_add_f32_dpp v27, v26, v26 quad_perm:[2,3,0,1] row_mask:0xf bank_mask:0xf
  v_cndmask_b32 v15, v15, v27, s[64:65]
  s_cbranch_scc1 L_a_37
  s_waitcnt vmcnt(3)
L_a_37:
  s_cbranch_vccnz L_b_38
  s_waitcnt vmcnt(4)
L_b_38:
  s_waitcnt vmcnt(6)
  buffer_load_dwordx4 v[152:155], v1, s[44:47], s14 offen nt
  v_add_u32 v1, s61, v1
  ds_read_b128 v[156:159], v42 offset:12288
  ds_read_b128 v[160:163], v42 offset:13312
  ds_read_b128 v[164:167], v42 offset:14336
  ds_read_b128 v[168:171], v42 offset:15360
  s_waitcnt lgkmcnt(4)
  v_dot2_f32_bf16 v20, v136, v8, 0
  v_dot2_f32_bf16 v21, v140, v8, 0
  v_dot2_f32_bf16 v22, v144, v8, 0
  v_dot2_f32_bf16 v23, v148, v8, 0
  v_dot2c_f32_bf16 v20, v137, v9
  v_dot2c_f32_bf16 v21, v141, v9
  v_dot2c_f32_bf16 v22, v145, v9
  v_dot2c_f32_bf16 v23, v149, v9
  v_dot2c_f32_bf16 v20, v138, v10
  v_dot2c_f32_bf16 v21, v142, v10
  v_dot2c_f32_bf16 v22, v146, v10
  v_dot2c_f32_bf16 v23, v150, v10
  v_dot2c_f32_bf16 v20, v139, v11
  v_dot2c_f32_bf16 v21, v143, v11
  v_dot2c_f32_bf16 v22, v147, v11
  v_dot2c_f32_bf16 v23, v151, v11
  v_add_f32_dpp v24, v20, v20 row_ror:8 row_mask:0xf bank_mask:0x3
  v_add_f32_dpp v24, v21, v21 row_ror:8 row_mask:0xf bank_mask:0xc
  v_add_f32_dpp v25, v22, v22 row_ror:8 row_mask:0xf bank_mask:0x3
  v_add_f32_dpp v25, v23, v23 row_ror:8 row_mask:0xf bank_mask:0xc
  v_add_f32_dpp v26, v24, v24 row_half_mirror row_mask:0xf bank_mask:0x5
  s_nop 0
  v_add_f32_dpp v26, v25, v25 row_half_mirror row_mask:0xf bank_mask:0xa
  s_nop 1
  v_add_f32_dpp v26, v26, v26 quad_perm:[1,0,3,2] row_mask:0xf bank_mask:0xf
  s_nop 1
  v_add_f32_dpp v27, v26, v26 quad_perm:[2,3,0,1] row_mask:0xf bank_mask:0xf
  v_cndmask_b32 v15, v15, v27, s[66:67]
  s_cbranch_scc1 L_a_39
  s_waitcnt vmcnt(3)
L_a_39:
  s_cbranch_vccnz L_b_40
  s_waitcnt vmcnt(4)
L_b_40:
  s_waitcnt vmcnt(6)
  buffer_load_dwordx4 v[172:175], v1, s[44:47], s14 offen nt
  v_add_u32 v1, s61, v1
  ds_read_b128 v[176:179], v42 offset:16384
  ds_read_b128 v[180:183], v42 offset:17408
  ds_read_b128 v[184:187], v42 offset:18432
  ds_read_b128 v[188:191], v42 offset:19456
  s_waitcnt lgkmcnt(4)
  v_dot2_f32_bf16 v20, v156, v8, 0
  v_dot2_f32_bf16 v21, v160, v8, 0
  v_dot2_f32_bf16 v22, v164, v8, 0
  v_dot2_f32_bf16 v23, v168, v8, 0
  v_dot2c_f32_bf16 v20, v157, v9
  v_dot2c_f32_bf16 v21, v161, v9
  v_dot2c_f32_bf16 v22, v165, v9
  v_dot2c_f32_bf16 v23, v169, v9
  v_dot2c_f32_bf16 v20, v158, v10
  v_dot2c_f32_bf16 v21, v162, v10
  v_dot2c_f32_bf16 v22, v166, v10
  v_dot2c_f32_bf16 v23, v170, v10
  v_dot2c_f32_bf16 v20, v159, v11
  v_dot2c_f32_bf16 v21, v163, v11
  v_dot2c_f32_bf16 v22, v167, v11
  v_dot2c_f32_bf16 v23, v171, v11
  v_add_f32_dpp v24, v20, v20 row_ror:8 row_mask:0xf bank_mask:0x3
  v_add_f32_dpp v24, v21, v21 row_ror:8 row_mask:0xf bank_mask:0xc
  v_add_f32_dpp v25, v22, v22 row_ror:8 row_mask:0xf bank_mask:0x3
  v_add_f32_dpp v25, v23, v23 row_ror:8 row_mask:0xf bank_mask:0xc
  v_add_f32_dpp v26, v24, v24 row_half_mirror row_mask:0xf bank_mask:0x5
  s_nop 0
  v_add_f32_dpp v26, v25, v25 row_half_mirror row_mask:0xf bank_mask:0xa
  s_nop 1
  v_add_f32_dpp v26, v26, v26 quad_perm:[1,0,3,2] row_mask:0xf bank_mask:0xf
  s_nop 1
  v_add_f32_dpp v16, v26, v26 quad_perm:[2,3,0,1] row_mask:0xf bank_mask:0xf
  s_cbranch_scc1 L_a_41
  s_waitcnt vmcnt(3)
L_a_41:
  s_cbranch_vccnz L_b_42
  s_waitcnt vmcnt(4)
L_b_42:
  s_waitcnt vmcnt(6)
  buffer_load_dwordx4 v[192:195], v1, s[44:47], s14 offen nt
  v_add_u32 v1, s61, v1
  ds_read_b128 v[196:199], v42 offset:20480
  ds_read_b128 v[200:203], v42 offset:21504
  ds_read_b128 v[204:207], v42 offset:22528
  ds_read_b128 v[208:211], v42 offset:23552
  s_waitcnt lgkmcnt(4)
  v_dot2_f32_bf16 v20, v176, v8, 0
  v_dot2_f32_bf16 v21, v180, v8, 0
  v_dot2_f32_bf16 v22, v184, v8, 0
  v_dot2_f32_bf16 v23, v188, v8, 0
  v_dot2c_f32_bf16 v20, v177, v9
  v_dot2c_f32_bf16 v21, v181, v9
  v_dot2c_f32_bf16 v22, v185, v9
  v_dot2c_f32_bf16 v23, v189, v9
  v_dot2c_f32_bf16 v20, v178, v10
  v_dot2c_f32_bf16 v21, v182, v10
  v_dot2c_f32_bf16 v22, v186, v10
  v_dot2c_f32_bf16 v23, v190, v10
  v_dot2c_f32_bf16 v20, v179, v11
  v_dot2c_f32_bf16 v21, v183, v11
  v_dot2c_f32_bf16 v22, v187, v11
  v_dot2c_f32_bf16 v23, v191, v11
  v_add_f32_dpp v24, v20, v20 row_ror:8 row_mask:0xf bank_mask:0x3
  v_add_f32_dpp v24, v21, v21 row_ror:8 row_mask:0xf bank_mask:0xc
  v_add_f32_dpp v25, v22, v22 row_ror:8 row_mask:0xf bank_mask:0x3
  v_add_f32_dpp v25, v23, v23 row_ror:8 row_mask:0xf bank_mask:0xc
  v_add_f32_dpp v26, v24, v24 row_half_mirror row_mask:0xf bank_mask:0x5
  s_nop 0
  v_add_f32_dpp v26, v25, v25 row_half_mirror row_mask:0xf bank_mask:0xa
  s_nop 1
  v_add_f32_dpp v26, v26, v26 quad_perm:[1,0,3,2] row_mask:0xf bank_mask:0xf
  s_nop 1
  v_add_f32_dpp v27, v26, v26 quad_perm:[2,3,0,1] row_mask:0xf bank_mask:0xf
  v_cndmask_b32 v16, v16, v27, s[62:63]
  s_cbranch_scc1 L_a_43
  s_waitcnt vmcnt(3)
L_a_43:
  s_cbranch_vccnz L_b_44
  s_waitcnt vmcnt(4)
L_b_44:
  s_waitcnt vmcnt(6)
  buffer_load_dwordx4 v[212:215], v1, s[44:47], s14 offen nt
  v_add_u32 v1, s61, v1
  ds_read_b128 v[216:219], v42 offset:24576
  ds_read_b128 v[220:223], v42 offset:25600
  ds_read_b128 v[224:227], v42 offset:26624
  ds_read_b128 v[228:231], v42 offset:27648
  s_waitcnt lgkmcnt(4)
  v_dot2_f32_bf16 v20, v196, v8, 0
  v_dot2_f32_bf16 v21, v200, v8, 0
  v_dot2_f32_bf16 v22, v204, v8, 0
  v_dot2_f32_bf16 v23, v208, v8, 0
  v_dot2c_f32_bf16 v20, v197, v9
  v_dot2c_f32_bf16 v21, v201, v9
  v_dot2c_f32_bf16 v22, v205, v9
  v_dot2c_f32_bf16 v23, v209, v9
  v_dot2c_f32_bf16 v20, v198, v10
  v_dot2c_f32_bf16 v21, v202, v10
  v_dot2c_f32_bf16 v22, v206, v10
  v_dot2c_f32_bf16 v23, v210, v10
  v_dot2c_f32_bf16 v20, v199, v11
  v_dot2c_f32_bf16 v21, v203, v11
  v_dot2c_f32_bf16 v22, v207, v11
  v_dot2c_f32_bf16 v23, v211, v11
  v_add_f32_dpp v24, v20, v20 row_ror:8 row_mask:0xf bank_mask:0x3
  v_add_f32_dpp v24, v21, v21 row_ror:8 row_mask:0xf bank_mask:0xc
  v_add_f32_dpp v25, v22, v22 row_ror:8 row_mask:0xf bank_mask:0x3
  v_add_f32_dpp v25, v23, v23 row_ror:8 row_mask:0xf bank_mask:0xc
  v_add_f32_dpp v26, v24, v24 row_half_mirror row_mask:0xf bank_mask:0x5
  s_nop 0
  v_add_f32_dpp v26, v25, v25 row_half_mirror row_mask:0xf bank_mask:0xa
  s_nop 1
  v_add_f32_dpp v26, v26, v26 quad_perm:[1,0,3,2] row_mask:0xf bank_mask:0xf
  s_nop 1
  v_add_f32_dpp v27, v26, v26 quad_perm:[2,3,0,1] row_mask:0xf bank_mask:0xf
  v_cndmask_b32 v16, v16, v27, s[64:65]
  s_cbranch_scc1 L_a_45
  s_waitcnt vmcnt(3)
L_a_45:
  s_cbranch_vccnz L_b_46
  s_waitcnt vmcnt(4)
L_b_46:
  s_waitcnt vmcnt(6)
  buffer_load_dwordx4 v[232:235], v1, s[44:47], s14 offen nt
  v_add_u32 v1, s61, v1
  ds_read_b128 v[236:239], v42 offset:28672
  ds_read_b128 v[240:243], v42 offset:29696
  ds_read_b128 v[244:247], v42 offset:30720
  ds_read_b128 v[248:251], v42 offset:31744
  s_waitcnt lgkmcnt(4)
  v_dot2_f32_bf16 v20, v216, v8, 0
  v_dot2_f32_bf16 v21, v220, v8, 0
  v_dot2_f32_bf16 v22, v224, v8, 0
  v_dot2_f32_bf16 v23, v228, v8, 0
  v_dot2c_f32_bf16 v20, v217, v9
  v_dot2c_f32_bf16 v21, v221, v9
  v_dot2c_f32_bf16 v22, v225, v9
  v_dot2c_f32_bf16 v23, v229, v9
  v_dot2c_f32_bf16 v20, v218, v10
  v_dot2c_f32_bf16 v21, v222, v10
  v_dot2c_f32_bf16 v22, v226, v10
  v_dot2c_f32_bf16 v23, v230, v10
  v_dot2c_f32_bf16 v20, v219, v11
  v_dot2c_f32_bf16 v21, v223, v11
  v_dot2c_f32_bf16 v22, v227, v11
  v_dot2c_f32_bf16 v23, v231, v11
  v_add_f32_dpp v24, v20, v20 row_ror:8 row_mask:0xf bank_mask:0x3
  v_add_f32_dpp v24, v21, v21 row_ror:8 row_mask:0xf bank_mask:0xc
  v_add_f32_dpp v25, v22, v22 row_ror:8 row_mask:0xf bank_mask:0x3
  v_add_f32_dpp v25, v23, v23 row_ror:8 row_mask:0xf bank_mask:0xc
  v_add_f32_dpp v26, v24, v24 row_half_mirror row_mask:0xf bank_mask:0x5
  s_nop 0
  v_add_f32_dpp v26, v25, v25 row_half_mirror row_mask:0xf bank_mask:0xa
  s_nop 1
  v_add_f32_dpp v26, v26, v26 quad_perm:[1,0,3,2] row_mask:0xf bank_mask:0xf
  s_nop 1
  v_add_f32_dpp v27, v26, v26 quad_perm:[2,3,0,1] row_mask:0xf bank_mask:0xf
  v_cndmask_b32 v16, v16, v27, s[66:67]
  s_cbranch_scc1 L_a_47
  s_waitcnt vmcnt(3)
L_a_47:
  s_cbranch_vccnz L_b_48
  s_waitcnt vmcnt(4)
L_b_48:
  s_waitcnt vmcnt(6)
  buffer_load_dwordx4 v[252:255], v1, s[44:47], s14 offen nt
  v_add_u32 v1, s61, v1
  s_waitcnt lgkmcnt(0)
  v_dot2_f32_bf16 v20, v236, v8, 0
  v_dot2_f32_bf16 v21, v240, v8, 0
  v_dot2_f32_bf16 v22, v244, v8, 0
  v_dot2_f32_bf16 v23, v248, v8, 0
  v_dot2c_f32_bf16 v20, v237, v9
  v_dot2c_f32_bf16 v21, v241, v9
  v_dot2c_f32_bf16 v22, v245, v9
  v_dot2c_f32_bf16 v23, v249, v9
  v_dot2c_f32_bf16 v20, v238, v10
  v_dot2c_f32_bf16 v21, v242, v10
  v_dot2c_f32_bf16 v22, v246, v10
  v_dot2c_f32_bf16 v23, v250, v10
  v_dot2c_f32_bf16 v20, v239, v11
  v_dot2c_f32_bf16 v21, v243, v11
  v_dot2c_f32_bf16 v22, v247, v11
  v_dot2c_f32_bf16 v23, v251, v11
  v_add_f32_dpp v24, v20, v20 row_ror:8 row_mask:0xf bank_mask:0x3
  v_add_f32_dpp v24, v21, v21 row_ror:8 row_mask:0xf bank_mask:0xc
  v_add_f32_dpp v25, v22, v22 row_ror:8 row_mask:0xf bank_mask:0x3
  v_add_f32_dpp v25, v23, v23 row_ror:8 row_mask:0xf bank_mask:0xc
  v_add_f32_dpp v26, v24, v24 row_half_mirror row_mask:0xf bank_mask:0x5
  s_nop 0
  v_add_f32_dpp v26, v25, v25 row_half_mirror row_mask:0xf bank_mask:0xa
  s_nop 1
  v_add_f32_dpp v26, v26, v26 quad_perm:[1,0,3,2] row_mask:0xf bank_mask:0xf
  s_nop 1
  v_add_f32_dpp v17, v26, v26 quad_perm:[2,3,0,1] row_mask:0xf bank_mask:0xf
  s_cbranch_scc1 L_a_49
  s_waitcnt vmcnt(3)
L_a_49:
  s_cbranch_vccnz L_b_50
  s_waitcnt vmcnt(4)
L_b_50:
  s_waitcnt vmcnt(6)
  buffer_load_dwordx4 v[100:103], v1, s[44:47], s14 offen nt
  v_add_u32 v1, s61, v1
  v_dot2_f32_bf16 v20, v48, v8, 0
  v_dot2_f32_bf16 v21, v52, v8, 0
  v_dot2_f32_bf16 v22, v56, v8, 0
  v_dot2_f32_bf16 v23, v60, v8, 0
  v_dot2c_f32_bf16 v20, v49, v9
  v_dot2c_f32_bf16 v21, v53, v9
  v_dot2c_f32_bf16 v22, v57, v9
  v_dot2c_f32_bf16 v23, v61, v9
  v_dot2c_f32_bf16 v20, v50, v10
  v_dot2c_f32_bf16 v21, v54, v10
  v_dot2c_f32_bf16 v22, v58, v10
  v_dot2c_f32_bf16 v23, v62, v10
  v_dot2c_f32_bf16 v20, v51, v11
  v_dot2c_f32_bf16 v21, v55, v11
  v_dot2c_f32_bf16 v22, v59, v11
  v_dot2c_f32_bf16 v23, v63, v11
  v_add_f32_dpp v24, v20, v20 row_ror:8 row_mask:0xf bank_mask:0x3
  v_add_f32_dpp v24, v21, v21 row_ror:8 row_mask:0xf bank_mask:0xc
  v_add_f32_dpp v25, v22, v22 row_ror:8 row_mask:0xf bank_mask:0x3
  v_add_f32_dpp v25, v23, v23 row_ror:8 row_mask:0xf bank_mask:0xc
  v_add_f32_dpp v26, v24, v24 row_half_mirror row_mask:0xf bank_mask:0x5
  s_nop 0
  v_add_f32_dpp v26, v25, v25 row_half_mirror row_mask:0xf bank_mask:0xa
  s_nop 1
  v_add_f32_dpp v26, v26, v26 quad_perm:[1,0,3,2] row_mask:0xf bank_mask:0xf
  s_nop 1
  v_add_f32_dpp v27, v26, v26 quad_perm:[2,3,0,1] row_mask:0xf bank_mask:0xf
  v_cndmask_b32 v17, v17, v27, s[62:63]
  s_cbranch_scc1 L_a_51
  s_waitcnt vmcnt(3)
L_a_51:
  s_cbranch_vccnz L_b_52
  s_waitcnt vmcnt(4)
L_b_52:
  s_waitcnt vmcnt(6)
  buffer_load_dwordx4 v[104:107], v1, s[44:47], s14 offen nt
  v_add_u32 v1, s61, v1
  v_dot2_f32_bf16 v20, v64, v8, 0
  v_dot2_f32_bf16 v21, v68, v8, 0
  v_dot2_f32_bf16 v22, v72, v8, 0
  v_dot2_f32_bf16 v23, v76, v8, 0
  v_dot2c_f32_bf16 v20, v65, v9
  v_dot2c_f32_bf16 v21, v69, v9
  v_dot2c_f32_bf16 v22, v73, v9
  v_dot2c_f32_bf16 v23, v77, v9
  v_dot2c_f32_bf16 v20, v66, v10
  v_dot2c_f32_bf16 v21, v70, v10
  v_dot2c_f32_bf16 v22, v74, v10
  v_dot2c_f32_bf16 v23, v78, v10
  v_dot2c_f32_bf16 v20, v67, v11
  v_dot2c_f32_bf16 v21, v71, v11
  v_dot2c_f32_bf16 v22, v75, v11
  v_dot2c_f32_bf16 v23, v79, v11
  v_add_f32_dpp v24, v20, v20 row_ror:8 row_mask:0xf bank_mask:0x3
  v_add_f32_dpp v24, v21, v21 row_ror:8 row_mask:0xf bank_mask:0xc
  v_add_f32_dpp v25, v22, v22 row_ror:8 row_mask:0xf bank_mask:0x3
  v_add_f32_dpp v25, v23, v23 row_ror:8 row_mask:0xf bank_mask:0xc
  v_add_f32_dpp v26, v24, v24 row_half_mirror row_mask:0xf bank_mask:0x5
  s_nop 0
  v_add_f32_dpp v26, v25, v25 row_half_mirror row_mask:0xf bank_mask:0xa
  s_nop 1
  v_add_f32_dpp v26, v26, v26 quad_perm:[1,0,3,2] row_mask:0xf bank_mask:0xf
  s_nop 1
  v_add_f32_dpp v27, v26, v26 quad_perm:[2,3,0,1] row_mask:0xf bank_mask:0xf
  v_cndmask_b32 v17, v17, v27, s[64:65]
  s_cmp_ge_i32 s60, 6
  s_cselect_b64 vcc, -1, 0
  s_cmp_ge_i32 s60, -6
  s_cbranch_scc1 L_a_53
  s_waitcnt vmcnt(3)
L_a_53:
  s_cbranch_vccnz L_b_54
  s_waitcnt vmcnt(4)
L_b_54:
  s_waitcnt vmcnt(6)
  buffer_load_dwordx4 v[108:111], v1, s[44:47], s14 offen nt
  v_add_u32 v1, s61, v1
  v_dot2_f32_bf16 v20, v80, v8, 0
  v_dot2_f32_bf16 v21, v84, v8, 0
  v_dot2_f32_bf16 v22, v88, v8, 0
  v_dot2_f32_bf16 v23, v92, v8, 0
  v_dot2c_f32_bf16 v20, v81, v9
  v_dot2c_f32_bf16 v21, v85, v9
  v_dot2c_f32_bf16 v22, v89, v9
  v_dot2c_f32_bf16 v23, v93, v9
  v_dot2c_f32_bf16 v20, v82, v10
  v_dot2c_f32_bf16 v21, v86, v10
  v_dot2c_f32_bf16 v22, v90, v10
  v_dot2c_f32_bf16 v23, v94, v10
  v_dot2c_f32_bf16 v20, v83, v11
  v_dot2c_f32_bf16 v21, v87, v11
  v_dot2c_f32_bf16 v22, v91, v11
  v_dot2c_f32_bf16 v23, v95, v11
  v_add_f32_dpp v24, v20, v20 row_ror:8 row_mask:0xf bank_mask:0x3
  v_add_f32_dpp v24, v21, v21 row_ror:8 row_mask:0xf bank_mask:0xc
  v_add_f32_dpp v25, v22, v22 row_ror:8 row_mask:0xf bank_mask:0x3
  v_add_f32_dpp v25, v23, v23 row_ror:8 row_mask:0xf bank_mask:0xc
  v_add_f32_dpp v26, v24, v24 row_half_mirror row_mask:0xf bank_mask:0x5
  s_nop 0
  v_add_f32_dpp v26, v25, v25 row_half_mirror row_mask:0xf bank_mask:0xa
  s_nop 1
  v_add_f32_dpp v26, v26, v26 quad_perm:[1,0,3,2] row_mask:0xf bank_mask:0xf
  s_nop 1
  v_add_f32_dpp v27, v26, v26 quad_perm:[2,3,0,1] row_mask:0xf bank_mask:0xf
  v_cndmask_b32 v17, v17, v27, s[66:67]
  s_cbranch_scc1 L_a_55
  s_waitcnt vmcnt(3)
L_a_55:
  s_cbranch_vccnz L_b_56
  s_waitcnt vmcnt(4)
L_b_56:
  s_waitcnt vmcnt(6)
  buffer_load_dwordx4 v[112:115], v1, s[44:47], s14 offen nt
  v_add_u32 v1, s61, v1
  v_dot2_f32_bf16 v20, v96, v8, 0
  v_dot2_f32_bf16 v21, v132, v8, 0
  v_dot2_f32_bf16 v22, v152, v8, 0
  v_dot2_f32_bf16 v23, v172, v8, 0
  v_dot2c_f32_bf16 v20, v97, v9
  v_dot2c_f32_bf16 v21, v133, v9
  v_dot2c_f32_bf16 v22, v153, v9
  v_dot2c_f32_bf16 v23, v173, v9
  v_dot2c_f32_bf16 v20, v98, v10
  v_dot2c_f32_bf16 v21, v134, v10
  v_dot2c_f32_bf16 v22, v154, v10
  v_dot2c_f32_bf16 v23, v174, v10
  v_dot2c_f32_bf16 v20, v99, v11
  v_dot2c_f32_bf16 v21, v135, v11
  v_dot2c_f32_bf16 v22, v155, v11
  v_dot2c_f32_bf16 v23, v175, v11
  v_add_f32_dpp v24, v20, v20 row_ror:8 row_mask:0xf bank_mask:0x3
  v_add_f32_dpp v24, v21, v21 row_ror:8 row_mask:0xf bank_mask:0xc
  v_add_f32_dpp v25, v22, v22 row_ror:8 row_mask:0xf bank_mask:0x3
  v_add_f32_dpp v25, v23, v23 row_ror:8 row_mask:0xf bank_mask:0xc
  v_add_f32_dpp v26, v24, v24 row_half_mirror row_mask:0xf bank_mask:0x5
  s_nop 0
  v_add_f32_dpp v26, v25, v25 row_half_mirror row_mask:0xf bank_mask:0xa
  s_nop 1
  v_add_f32_dpp v26, v26, v26 quad_perm:[1,0,3,2] row_mask:0xf bank_mask:0xf
  s_nop 1
  v_add_f32_dpp v18, v26, v26 quad_perm:[2,3,0,1] row_mask:0xf bank_mask:0xf
  s_cbranch_scc1 L_a_57
  s_waitcnt vmcnt(3)
L_a_57:
  s_cbranch_vccnz L_b_58
  s_waitcnt vmcnt(4)
L_b_58:
  s_waitcnt vmcnt(6)
  buffer_load_dwordx4 v[116:119], v1, s[44:47], s14 offen nt
  v_add_u32 v1, s61, v1
  s_cmp_ge_i32 s60, 8
  s_cselect_b64 vcc, -1, 0
  s_cmp_ge_i32 s60, -8
  s_cbranch_scc1 L_a_59
  s_waitcnt vmcnt(3)
L_a_59:
  s_cbranch_vccnz L_b_60
  s_waitcnt vmcnt(4)
L_b_60:
  s_waitcnt vmcnt(6)
  buffer_load_dwordx4 v[120:123], v1, s[44:47], s14 offen nt
  v_add_u32 v1, s61, v1
  s_cbranch_scc1 L_a_61
  s_waitcnt vmcnt(3)
L_a_61:
  s_cbranch_vccnz L_b_62
  s_waitcnt vmcnt(4)
L_b_62:
  s_waitcnt vmcnt(6)
  buffer_load_dwordx4 v[124:127], v1, s[44:47], s14 offen nt
  v_add_u32 v1, s61, v1
  v_dot2_f32_bf16 v20, v192, v8, 0
  v_dot2_f32_bf16 v21, v212, v8, 0
  v_dot2_f32_bf16 v22, v232, v8, 0
  v_dot2_f32_bf16 v23, v252, v8, 0
  v_dot2c_f32_bf16 v20, v193, v9
  v_dot2c_f32_bf16 v21, v213, v9
  v_dot2c_f32_bf16 v22, v233, v9
  v_dot2c_f32_bf16 v23, v253, v9
  v_dot2c_f32_bf16 v20, v194, v10
  v_dot2c_f32_bf16 v21, v214, v10
  v_dot2c_f32_bf16 v22, v234, v10
  v_dot2c_f32_bf16 v23, v254, v10
  v_dot2c_f32_bf16 v20, v195, v11
  v_dot2c_f32_bf16 v21, v215, v11
  v_dot2c_f32_bf16 v22, v235, v11
  v_dot2c_f32_bf16 v23, v255, v11
  v_add_f32_dpp v24, v20, v20 row_ror:8 row_mask:0xf bank_mask:0x3
  v_add_f32_dpp v24, v21, v21 row_ror:8 row_mask:0xf bank_mask:0xc
  v_add_f32_dpp v25, v22, v22 row_ror:8 row_mask:0xf bank_mask:0x3
  v_add_f32_dpp v25, v23, v23 row_ror:8 row_mask:0xf bank_mask:0xc
  v_add_f32_dpp v26, v24, v24 row_half_mirror row_mask:0xf bank_mask:0x5
  s_nop 0
  v_add_f32_dpp v26, v25, v25 row_half_mirror row_mask:0xf bank_mask:0xa
  s_nop 1
  v_add_f32_dpp v26, v26, v26 quad_perm:[1,0,3,2] row_mask:0xf bank_mask:0xf
  s_nop 1
  v_add_f32_dpp v27, v26, v26 quad_perm:[2,3,0,1] row_mask:0xf bank_mask:0xf
  v_cndmask_b32 v18, v18, v27, s[62:63]
  s_cbranch_scc1 L_a_63
  s_waitcnt vmcnt(3)
L_a_63:
  s_cbranch_vccnz L_b_64
  s_waitcnt vmcnt(4)
L_b_64:
  s_waitcnt vmcnt(6)
  buffer_load_dwordx4 v[128:131], v1, s[44:47], s14 offen nt
  v_add_u32 v1, s61, v1
  s_cmp_ge_i32 s60, 9
  s_cselect_b64 vcc, -1, 0
  s_cmp_ge_i32 s60, -9
  s_cbranch_scc1 L_a_65
  s_waitcnt vmcnt(3)
L_a_65:
  s_cbranch_vccnz L_b_66
  s_waitcnt vmcnt(4)
L_b_66:
  s_waitcnt vmcnt(6)
  buffer_load_dwordx4 v[136:139], v1, s[44:47], s14 offen nt
  v_add_u32 v1, s61, v1
  s_cbranch_scc1 L_a_67
  s_waitcnt vmcnt(3)
L_a_67:
  s_cbranch_vccnz L_b_68
  s_waitcnt vmcnt(4)
L_b_68:
  s_waitcnt vmcnt(6)
  buffer_load_dwordx4 v[140:143], v1, s[44:47], s14 offen nt
  v_add_u32 v1, s61, v1
  s_cbranch_scc1 L_a_69
  s_waitcnt vmcnt(3)
L_a_69:
  s_cbranch_vccnz L_b_70
  s_waitcnt vmcnt(4)
L_b_70:
  s_waitcnt vmcnt(6)
  buffer_load_dwordx4 v[144:147], v1, s[44:47], s14 offen nt
  v_add_u32 v1, s61, v1
  v_dot2_f32_bf16 v20, v100, v8, 0
  v_dot2_f32_bf16 v21, v104, v8, 0
  v_dot2_f32_bf16 v22, v108, v8, 0
  v_dot2_f32_bf16 v23, v112, v8, 0
  v_dot2c_f32_bf16 v20, v101, v9
  v_dot2c_f32_bf16 v21, v105, v9
  v_dot2c_f32_bf16 v22, v109, v9
  v_dot2c_f32_bf16 v23, v113, v9
  v_dot2c_f32_bf16 v20, v102, v10
  v_dot2c_f32_bf16 v21, v106, v10
  v_dot2c_f32_bf16 v22, v110, v10
  v_dot2c_f32_bf16 v23, v114, v10
  v_dot2c_f32_bf16 v20, v103, v11
  v_dot2c_f32_bf16 v21, v107, v11
  v_dot2c_f32_bf16 v22, v111, v11
  v_dot2c_f32_bf16 v23, v115, v11
  v_add_f32_dpp v24, v20, v20 row_ror:8 row_mask:0xf bank_mask:0x3
  v_add_f32_dpp v24, v21, v21 row_ror:8 row_mask:0xf bank_mask:0xc
  v_add_f32_dpp v25, v22, v22 row_ror:8 row_mask:0xf bank_mask:0x3
  v_add_f32_dpp v25, v23, v23 row_ror:8 row_mask:0xf bank_mask:0xc
  v_add_f32_dpp v26, v24, v24 row_half_mirror row_mask:0xf bank_mask:0x5
  s_nop 0
  v_add_f32_dpp v26, v25, v25 row_half_mirror row_mask:0xf bank_mask:0xa
  s_nop 1
  v_add_f32_dpp v26, v26, v26 quad_perm:[1,0,3,2] row_mask:0xf bank_mask:0xf
  s_nop 1
  v_add_f32_dpp v27, v26, v26 quad_perm:[2,3,0,1] row_mask:0xf bank_mask:0xf
  v_cndmask_b32 v18, v18, v27, s[64:65]
  s_cmp_ge_i32 s60, 11
  s_cselect_b64 vcc, -1, 0
  s_cmp_ge_i32 s60, -11
  s_cbranch_scc1 L_a_71
  s_waitcnt vmcnt(3)
L_a_71:
  s_cbranch_vccnz L_b_72
  s_waitcnt vmcnt(4)
L_b_72:
  s_waitcnt vmcnt(6)
  buffer_load_dwordx4 v[148:151], v1, s[44:47], s14 offen nt
  v_add_u32 v1, s61, v1
  s_cbranch_scc1 L_a_73
  s_waitcnt vmcnt(3)
L_a_73:
  s_cbranch_vccnz L_b_74
  s_waitcnt vmcnt(4)
L_b_74:
  s_waitcnt vmcnt(6)
  buffer_load_dwordx4 v[156:159], v1, s[44:47], s14 offen nt
  v_add_u32 v1, s61, v1
  s_cbranch_scc1 L_a_75
  s_waitcnt vmcnt(3)
L_a_75:
  s_cbranch_vccnz L_b_76
  s_waitcnt vmcnt(4)
L_b_76:
  s_waitcnt vmcnt(6)
  buffer_load_dwordx4 v[160:163], v1, s[44:47], s14 offen nt
  v_add_u32 v1, s61, v1
  s_cmp_ge_i32 s60, 12
  s_cselect_b64 vcc, -1, 0
  s_cmp_ge_i32 s60, -12
  s_cbranch_scc1 L_a_77
  s_waitcnt vmcnt(3)
L_a_77:
  s_cbranch_vccnz L_b_78
  s_waitcnt vmcnt(4)
L_b_78:
  s_waitcnt vmcnt(6)
  buffer_load_dwordx4 v[164:167], v1, s[44:47], s14 offen nt
  v_add_u32 v1, s61, v1
  v_dot2_f32_bf16 v20, v116, v8, 0
  v_dot2_f32_bf16 v21, v120, v8, 0
  v_dot2_f32_bf16 v22, v124, v8, 0
  v_dot2_f32_bf16 v23, v128, v8, 0
  v_dot2c_f32_bf16 v20, v117, v9
  v_dot2c_f32_bf16 v21, v121, v9
  v_dot2c_f32_bf16 v22, v125, v9
  v_dot2c_f32_bf16 v23, v129, v9
  v_dot2c_f32_bf16 v20, v118, v10
  v_dot2c_f32_bf16 v21, v122, v10
  v_dot2c_f32_bf16 v22, v126, v10
  v_dot2c_f32_bf16 v23, v130, v10
  v_dot2c_f32_bf16 v20, v119, v11
  v_dot2c_f32_bf16 v21, v123, v11
  v_dot2c_f32_bf16 v22, v127, v11
  v_dot2c_f32_bf16 v23, v131, v11
  v_add_f32_dpp v24, v20, v20 row_ror:8 row_mask:0xf bank_mask:0x3
  v_add_f32_dpp v24, v21, v21 row_ror:8 row_mask:0xf bank_mask:0xc
  v_add_f32_dpp v25, v22, v22 row_ror:8 row_mask:0xf bank_mask:0x3
  v_add_f32_dpp v25, v23, v23 row_ror:8 row_mask:0xf bank_mask:0xc
  v_add_f32_dpp v26, v24, v24 row_half_mirror row_mask:0xf bank_mask:0x5
  s_nop 0
  v_add_f32_dpp v26, v25, v25 row_half_mirror row_mask:0xf bank_mask:0xa
  s_nop 1
  v_add_f32_dpp v26, v26, v26 quad_perm:[1,0,3,2] row_mask:0xf bank_mask:0xf
  s_nop 1
  v_add_f32_dpp v27, v26, v26 quad_perm:[2,3,0,1] row_mask:0xf bank_mask:0xf
  v_cndmask_b32 v18, v18, v27, s[66:67]
  s_cbranch_scc1 L_a_79
  s_waitcnt vmcnt(3)
L_a_79:
  s_cbranch_vccnz L_b_80
  s_waitcnt vmcnt(4)
L_b_80:
  s_waitcnt vmcnt(6)
  buffer_load_dwordx4 v[168:171], v1, s[44:47], s14 offen nt
  v_add_u32 v1, s61, v1
  v_mov_b32 v47, 1
  s_mov_b64 exec, 1
  buffer_atomic_add v47, v45, s[52:55], s56 offen offset:256 sc0
  s_mov_b64 exec, -1
  s_cbranch_scc1 L_a_81
  s_waitcnt vmcnt(4)
L_a_81:
  s_cbranch_vccnz L_b_82
  s_waitcnt vmcnt(5)
L_b_82:
  s_waitcnt vmcnt(7)
  buffer_load_dwordx4 v[176:179], v1, s[44:47], s14 offen nt
  v_add_u32 v1, s61, v1
  s_cmp_ge_i32 s60, 14
  s_cselect_b64 vcc, -1, 0
  s_cmp_ge_i32 s60, -14
  s_cbranch_scc1 L_a_83
  s_waitcnt vmcnt(4)
L_a_83:
  s_cbranch_vccnz L_b_84
  s_waitcnt vmcnt(5)
L_b_84:
  s_waitcnt vmcnt(7)
  buffer_load_dwordx4 v[180:183], v1, s[44:47], s14 offen nt
  v_add_u32 v1, s61, v1
  s_cbranch_scc1 L_a_85
  s_waitcnt vmcnt(4)
L_a_85:
  s_cbranch_vccnz L_b_86
  s_waitcnt vmcnt(5)
L_b_86:
  s_waitcnt vmcnt(7)
  buffer_load_dwordx4 v[184:187], v1, s[44:47], s14 offen nt
  v_add_u32 v1, s61, v1
  v_dot2_f32_bf16 v20, v136, v8, 0
  v_dot2_f32_bf16 v21, v140, v8, 0
  v_dot2_f32_bf16 v22, v144, v8, 0
  v_dot2_f32_bf16 v23, v148, v8, 0
  v_dot2c_f32_bf16 v20, v137, v9
  v_dot2c_f32_bf16 v21, v141, v9
  v_dot2c_f32_bf16 v22, v145, v9
  v_dot2c_f32_bf16 v23, v149, v9
  v_dot2c_f32_bf16 v20, v138, v10
  v_dot2c_f32_bf16 v21, v142, v10
  v_dot2c_f32_bf16 v22, v146, v10
  v_dot2c_f32_bf16 v23, v150, v10
  v_dot2c_f32_bf16 v20, v139, v11
  v_dot2c_f32_bf16 v21, v143, v11
  v_dot2c_f32_bf16 v22, v147, v11
  v_dot2c_f32_bf16 v23, v151, v11
  v_add_f32_dpp v24, v20, v20 row_ror:8 row_mask:0xf bank_mask:0x3
  v_add_f32_dpp v24, v21, v21 row_ror:8 row_mask:0xf bank_mask:0xc
  v_add_f32_dpp v25, v22, v22 row_ror:8 row_mask:0xf bank_mask:0x3
  v_add_f32_dpp v25, v23, v23 row_ror:8 row_mask:0xf bank_mask:0xc
  v_add_f32_dpp v26, v24, v24 row_half_mirror row_mask:0xf bank_mask:0x5
  s_nop 0
  v_add_f32_dpp v26, v25, v25 row_half_mirror row_mask:0xf bank_mask:0xa
  s_nop 1
  v_add_f32_dpp v26, v26, v26 quad_perm:[1,0,3,2] row_mask:0xf bank_mask:0xf
  s_nop 1
  v_add_f32_dpp v19, v26, v26 quad_perm:[2,3,0,1] row_mask:0xf bank_mask:0xf
  s_cbranch_scc1 L_a_87
  s_waitcnt vmcnt(4)
L_a_87:
  s_cbranch_vccnz L_b_88
  s_waitcnt vmcnt(5)
L_b_88:
  s_waitcnt vmcnt(7)
  buffer_load_dwordx4 v[188:191], v1, s[44:47], s14 offen nt
  v_add_u32 v1, s61, v1
  s_cmp_ge_i32 s60, 15
  s_cselect_b64 vcc, -1, 0
  s_cmp_ge_i32 s60, -15
  s_cbranch_scc1 L_a_89
  s_waitcnt vmcnt(3)
L_a_89:
  s_cbranch_vccnz L_b_90
  s_waitcnt vmcnt(5)
L_b_90:
  s_waitcnt vmcnt(7)
  buffer_load_dwordx4 v[196:199], v1, s[44:47], s14 offen nt
  v_add_u32 v1, s61, v1
  s_cbranch_scc1 L_a_91
  s_waitcnt vmcnt(3)
L_a_91:
  s_cbranch_vccnz L_b_92
  s_waitcnt vmcnt(4)
L_b_92:
  s_waitcnt vmcnt(7)
  buffer_load_dwordx4 v[200:203], v1, s[44:47], s14 offen nt
  v_add_u32 v1, s61, v1
  s_cbranch_scc1 L_a_93
  s_waitcnt vmcnt(3)
L_a_93:
  s_cbranch_vccnz L_b_94
  s_waitcnt vmcnt(4)
L_b_94:
  s_waitcnt vmcnt(7)
  buffer_load_dwordx4 v[204:207], v1, s[44:47], s14 offen nt
  v_add_u32 v1, s61, v1
  v_dot2_f32_bf16 v20, v156, v8, 0
  v_dot2_f32_bf16 v21, v160, v8, 0
  v_dot2_f32_bf16 v22, v164, v8, 0
  v_dot2_f32_bf16 v23, v168, v8, 0
  v_dot2c_f32_bf16 v20, v157, v9
  v_dot2c_f32_bf16 v21, v161, v9
  v_dot2c_f32_bf16 v22, v165, v9
  v_dot2c_f32_bf16 v23, v169, v9
  v_dot2c_f32_bf16 v20, v158, v10
  v_dot2c_f32_bf16 v21, v162, v10
  v_dot2c_f32_bf16 v22, v166, v10
  v_dot2c_f32_bf16 v23, v170, v10
  v_dot2c_f32_bf16 v20, v159, v11
  v_dot2c_f32_bf16 v21, v163, v11
  v_dot2c_f32_bf16 v22, v167, v11
  v_dot2c_f32_bf16 v23, v171, v11
  v_add_f32_dpp v24, v20, v20 row_ror:8 row_mask:0xf bank_mask:0x3
  v_add_f32_dpp v24, v21, v21 row_ror:8 row_mask:0xf bank_mask:0xc
  v_add_f32_dpp v25, v22, v22 row_ror:8 row_mask:0xf bank_mask:0x3
  v_add_f32_dpp v25, v23, v23 row_ror:8 row_mask:0xf bank_mask:0xc
  v_add_f32_dpp v26, v24, v24 row_half_mirror row_mask:0xf bank_mask:0x5
  s_nop 0
  v_add_f32_dpp v26, v25, v25 row_half_mirror row_mask:0xf bank_mask:0xa
  s_nop 1
  v_add_f32_dpp v26, v26, v26 quad_perm:[1,0,3,2] row_mask:0xf bank_mask:0xf
  s_nop 1
  v_add_f32_dpp v27, v26, v26 quad_perm:[2,3,0,1] row_mask:0xf bank_mask:0xf
  v_cndmask_b32 v19, v19, v27, s[62:63]
  s_cmp_ge_i32 s60, 17
  s_cselect_b64 vcc, -1, 0
  s_cmp_ge_i32 s60, -17
  s_cbranch_scc1 L_a_95
  s_waitcnt vmcnt(3)
L_a_95:
  s_cbranch_vccnz L_b_96
  s_waitcnt vmcnt(4)
L_b_96:
  s_waitcnt vmcnt(6)
  buffer_load_dwordx4 v[208:211], v1, s[44:47], s14 offen nt
  v_subrev_u32 v47, 32, v47
  s_mov_b64 exec, 1
  ds_write_b32 v44, v47 offset:20
  s_mov_b64 exec, -1
  s_mov_b32 s14, s15
  v_lshlrev_b32 v1, 4, v0
  s_cbranch_scc1 L_a_97
  s_waitcnt vmcnt(3)
L_a_97:
  s_cbranch_vccnz L_b_98
  s_waitcnt vmcnt(4)
L_b_98:
  s_waitcnt vmcnt(6)
  buffer_load_dwordx4 v[216:219], v1, s[48:51], s14 offen nt
  v_add_u32 v1, s61, v1
  ds_read_b32 v46, v2 offset:20
  s_waitcnt lgkmcnt(0)
  v_readfirstlane_b32 s60, v46
  s_cmp_ge_i32 s60, 5
  s_cselect_b64 vcc, -1, 0
  s_cmp_ge_i32 s60, -5
  s_cbranch_scc1 L_a_99
  s_waitcnt vmcnt(3)
L_a_99:
  s_cbranch_vccnz L_b_100
  s_waitcnt vmcnt(4)
L_b_100:
  s_waitcnt vmcnt(6)
  buffer_load_dwordx4 v[220:223], v1, s[48:51], s14 offen nt
  v_add_u32 v1, s61, v1
  s_cbranch_scc1 L_a_101
  s_waitcnt vmcnt(3)
L_a_101:
  s_cbranch_vccnz L_b_102
  s_waitcnt vmcnt(4)
L_b_102:
  s_waitcnt vmcnt(6)
  buffer_load_dwordx4 v[224:227], v1, s[48:51], s14 offen nt
  v_add_u32 v1, s61, v1
  v_dot2_f32_bf16 v20, v176, v8, 0
  v_dot2_f32_bf16 v21, v180, v8, 0
  v_dot2_f32_bf16 v22, v184, v8, 0
  v_dot2_f32_bf16 v23, v188, v8, 0
  v_dot2c_f32_bf16 v20, v177, v9
  v_dot2c_f32_bf16 v21, v181, v9
  v_dot2c_f32_bf16 v22, v185, v9
  v_dot2c_f32_bf16 v23, v189, v9
  v_dot2c_f32_bf16 v20, v178, v10
  v_dot2c_f32_bf16 v21, v182, v10
  v_dot2c_f32_bf16 v22, v186, v10
  v_dot2c_f32_bf16 v23, v190, v10
  v_dot2c_f32_bf16 v20, v179, v11
  v_dot2c_f32_bf16 v21, v183, v11
  v_dot2c_f32_bf16 v22, v187, v11
  v_dot2c_f32_bf16 v23, v191, v11
  v_add_f32_dpp v24, v20, v20 row_ror:8 row_mask:0xf bank_mask:0x3
  v_add_f32_dpp v24, v21, v21 row_ror:8 row_mask:0xf bank_mask:0xc
  v_add_f32_dpp v25, v22, v22 row_ror:8 row_mask:0xf bank_mask:0x3
  v_add_f32_dpp v25, v23, v23 row_ror:8 row_mask:0xf bank_mask:0xc
  v_add_f32_dpp v26, v24, v24 row_half_mirror row_mask:0xf bank_mask:0x5
  s_nop 0
  v_add_f32_dpp v26, v25, v25 row_half_mirror row_mask:0xf bank_mask:0xa
  s_nop 1
  v_add_f32_dpp v26, v26, v26 quad_perm:[1,0,3,2] row_mask:0xf bank_mask:0xf
  s_nop 1
  v_add_f32_dpp v27, v26, v26 quad_perm:[2,3,0,1] row_mask:0xf bank_mask:0xf
  v_cndmask_b32 v19, v19, v27, s[64:65]
  s_cbranch_scc1 L_a_103
  s_waitcnt vmcnt(3)
L_a_103:
  s_cbranch_vccnz L_b_104
  s_waitcnt vmcnt(4)
L_b_104:
  s_waitcnt vmcnt(6)
  buffer_load_dwordx4 v[228:231], v1, s[48:51], s14 offen nt
  v_add_u32 v1, s61, v1
  ds_read_b32 v46, v2 offset:20
  s_waitcnt lgkmcnt(0)
  v_readfirstlane_b32 s60, v46
  s_cmp_ge_i32 s60, 5
  s_cselect_b64 vcc, -1, 0
  s_cmp_ge_i32 s60, -5
  s_cbranch_scc1 L_a_105
  s_waitcnt vmcnt(3)
L_a_105:
  s_cbranch_vccnz L_b_106
  s_waitcnt vmcnt(4)
L_b_106:
  s_waitcnt vmcnt(6)
  buffer_load_dwordx4 v[236:239], v1, s[48:51], s14 offen nt
  v_add_u32 v1, s61, v1
  s_cbranch_scc1 L_a_107
  s_waitcnt vmcnt(3)
L_a_107:
  s_cbranch_vccnz L_b_108
  s_waitcnt vmcnt(4)
L_b_108:
  s_waitcnt vmcnt(6)
  buffer_load_dwordx4 v[240:243], v1, s[48:51], s14 offen nt
  v_add_u32 v1, s61, v1
  s_cbranch_scc1 L_a_109
  s_waitcnt vmcnt(3)
L_a_109:
  s_cbranch_vccnz L_b_110
  s_waitcnt vmcnt(4)
L_b_110:
  s_waitcnt vmcnt(6)
  buffer_load_dwordx4 v[244:247], v1, s[48:51], s14 offen nt
  v_add_u32 v1, s61, v1
  v_dot2_f32_bf16 v20, v196, v8, 0
  v_dot2_f32_bf16 v21, v200, v8, 0
  v_dot2_f32_bf16 v22, v204, v8, 0
  v_dot2_f32_bf16 v23, v208, v8, 0
  v_dot2c_f32_bf16 v20, v197, v9
  v_dot2c_f32_bf16 v21, v201, v9
  v_dot2c_f32_bf16 v22, v205, v9
  v_dot2c_f32_bf16 v23, v209, v9
  v_dot2c_f32_bf16 v20, v198, v10
  v_dot2c_f32_bf16 v21, v202, v10
  v_dot2c_f32_bf16 v22, v206, v10
  v_dot2c_f32_bf16 v23, v210, v10
  v_dot2c_f32_bf16 v20, v199, v11
  v_dot2c_f32_bf16 v21, v203, v11
  v_dot2c_f32_bf16 v22, v207, v11
  v_dot2c_f32_bf16 v23, v211, v11
  v_add_f32_dpp v24, v20, v20 row_ror:8 row_mask:0xf bank_mask:0x3
  v_add_f32_dpp v24, v21, v21 row_ror:8 row_mask:0xf bank_mask:0xc
  v_add_f32_dpp v25, v22, v22 row_ror:8 row_mask:0xf bank_mask:0x3
  v_add_f32_dpp v25, v23, v23 row_ror:8 row_mask:0xf bank_mask:0xc
  v_add_f32_dpp v26, v24, v24 row_half_mirror row_mask:0xf bank_mask:0x5
  s_nop 0
  v_add_f32_dpp v26, v25, v25 row_half_mirror row_mask:0xf bank_mask:0xa
  s_nop 1
  v_add_f32_dpp v26, v26, v26 quad_perm:[1,0,3,2] row_mask:0xf bank_mask:0xf
  s_nop 1
  v_add_f32_dpp v27, v26, v26 quad_perm:[2,3,0,1] row_mask:0xf bank_mask:0xf
  v_cndmask_b32 v19, v19, v27, s[66:67]
  s_cbranch_scc1 L_a_111
  s_waitcnt vmcnt(3)
L_a_111:
  s_cbranch_vccnz L_b_112
  s_waitcnt vmcnt(4)
L_b_112:
  s_waitcnt vmcnt(6)
  buffer_load_dwordx4 v[248:251], v1, s[48:51], s14 offen nt
  v_add_u32 v1, s61, v1
  s_mov_b32 s10, 0x3db504f3
  v_cvt_pk_bf16_f32 v40, v12, v13
  v_lshlrev_b32 v12, 16, v40
  v_and_b32 v13, s70, v40
  v_mul_f32 v12, s10, v12
  v_mul_f32 v13, s10, v13
  v_cvt_pk_bf16_f32 v40, v12, v13
  v_lshlrev_b32 v12, 16, v40
  v_and_b32 v13, s70, v40
  v_cvt_pk_bf16_f32 v40, v14, v15
  v_lshlrev_b32 v14, 16, v40
  v_and_b32 v15, s70, v40
  v_mul_f32 v14, s10, v14
  v_mul_f32 v15, s10, v15
  v_cvt_pk_bf16_f32 v40, v14, v15
  v_lshlrev_b32 v14, 16, v40
  v_and_b32 v15, s70, v40
  v_cvt_pk_bf16_f32 v40, v16, v17
  v_lshlrev_b32 v16, 16, v40
  v_and_b32 v17, s70, v40
  v_mul_f32 v16, s10, v16
  v_mul_f32 v17, s10, v17
  v_cvt_pk_bf16_f32 v40, v16, v17
  v_lshlrev_b32 v16, 16, v40
  v_and_b32 v17, s70, v40
  v_cvt_pk_bf16_f32 v40, v18, v19
  v_lshlrev_b32 v18, 16, v40
  v_and_b32 v19, s70, v40
  v_mul_f32 v18, s10, v18
  v_mul_f32 v19, s10, v19
  v_cvt_pk_bf16_f32 v40, v18, v19
  v_lshlrev_b32 v18, 16, v40
  v_and_b32 v19, s70, v40
  s_cbranch_scc1 L_a_113
  s_waitcnt vmcnt(3)
L_a_113:
  s_cbranch_vccnz L_b_114
  s_waitcnt vmcnt(4)
L_b_114:
  s_waitcnt vmcnt(6)
  buffer_load_dwordx4 v[48:51], v1, s[48:51], s14 offen nt
  v_add_u32 v1, s61, v1
  v_max3_f32 v24, v12, v13, v14
  v_max3_f32 v24, v24, v15, v16
  v_max3_f32 v24, v24, v17, v18
  v_max_f32 v24, v24, v19
  s_nop 1
  v_max_f32_dpp v24, v24, v24 row_ror:8 row_mask:0xf bank_mask:0xf
  s_nop 1
  v_max_f32_dpp v24, v24, v24 row_ror:4 row_mask:0xf bank_mask:0xf
  s_nop 1
  v_max_f32_dpp v24, v24, v24 row_ror:2 row_mask:0xf bank_mask:0xf
  s_nop 1
  v_max_f32_dpp v24, v24, v24 row_ror:1 row_mask:0xf bank_mask:0xf
  s_nop 0
  v_readlane_b32 s10, v24, 0
  v_readlane_b32 s11, v24, 16
  v_readlane_b32 s12, v24, 32
  v_readlane_b32 s13, v24, 48
  v_mov_b32 v24, s10
  v_max_f32 v24, s11, v24
  v_max_f32 v24, s12, v24
  v_max_f32 v24, s13, v24
  v_sub_f32 v28, v12, v24
  v_mul_f32 v28, s71, v28
  v_sub_f32 v29, v13, v24
  v_mul_f32 v29, s71, v29
  v_sub_f32 v30, v14, v24
  v_mul_f32 v30, s71, v30
  v_sub_f32 v31, v15, v24
  v_mul_f32 v31, s71, v31
  v_sub_f32 v32, v16, v24
  v_mul_f32 v32, s71, v32
  v_sub_f32 v33, v17, v24
  v_mul_f32 v33, s71, v33
  v_sub_f32 v34, v18, v24
  v_mul_f32 v34, s71, v34
  v_sub_f32 v35, v19, v24
  v_mul_f32 v35, s71, v35
  s_cbranch_scc1 L_a_115
  s_waitcnt vmcnt(3)
L_a_115:
  s_cbranch_vccnz L_b_116
  s_waitcnt vmcnt(4)
L_b_116:
  s_waitcnt vmcnt(6)
  buffer_load_dwordx4 v[52:55], v1, s[48:51], s14 offen nt
  v_add_u32 v1, s61, v1
  v_exp_f32 v28, v28
  v_exp_f32 v29, v29
  v_exp_f32 v30, v30
  v_exp_f32 v31, v31
  v_exp_f32 v32, v32
  v_exp_f32 v33, v33
  v_exp_f32 v34, v34
  v_exp_f32 v35, v35
  v_add_f32 v26, v28, v29
  v_add_f32 v26, v26, v30
  v_add_f32 v26, v26, v31
  v_add_f32 v26, v26, v32
  v_add_f32 v26, v26, v33
  v_add_f32 v26, v26, v34
  v_add_f32 v26, v26, v35
  s_nop 1
  v_add_f32_dpp v26, v26, v26 row_ror:8 row_mask:0xf bank_mask:0xf
  s_nop 1
  v_add_f32_dpp v26, v26, v26 row_ror:4 row_mask:0xf bank_mask:0xf
  s_nop 1
  v_add_f32_dpp v26, v26, v26 row_ror:2 row_mask:0xf bank_mask:0xf
  s_nop 1
  v_add_f32_dpp v26, v26, v26 row_ror:1 row_mask:0xf bank_mask:0xf
  s_nop 0
  v_readlane_b32 s10, v26, 0
  v_readlane_b32 s11, v26, 16
  v_readlane_b32 s12, v26, 32
  v_readlane_b32 s13, v26, 48
  v_mov_b32 v26, s10
  v_add_f32 v26, s11, v26
  v_add_f32 v26, s12, v26
  v_add_f32 v26, s13, v26
  v_mov_b32 v25, s7
  v_mov_b32 v27, s7
  s_lshl_b32 s13, s100, 7
  s_add_u32 s13, s13, 4096
  s_lshl_b32 s10, s6, 2
  s_add_u32 s10, s10, s9
  s_lshl_b32 s10, s10, 4
  s_add_u32 s10, s10, s13
  s_mov_b64 exec, 1
  buffer_store_dwordx4 v[24:27], v2, s[52:55], s10 offen sc1
  s_mov_b64 exec, -1
  v_and_b32 v3, 7, v0
  v_lshlrev_b32 v3, 4, v3
  s_cmp_ge_i32 s60, 6
  s_cselect_b64 vcc, -1, 0
  s_cmp_ge_i32 s60, -6
  s_cbranch_scc1 L_a_117
  s_waitcnt vmcnt(4)
L_a_117:
  s_cbranch_vccnz L_b_118
  s_waitcnt vmcnt(5)
L_b_118:
  s_waitcnt vmcnt(7)
  buffer_load_dwordx4 v[56:59], v1, s[48:51], s14 offen nt
  v_add_u32 v1, s61, v1
  s_cbranch_scc1 L_a_119
  s_waitcnt vmcnt(4)
L_a_119:
  s_cbranch_vccnz L_b_120
  s_waitcnt vmcnt(5)
L_b_120:
  s_waitcnt vmcnt(7)
  buffer_load_dwordx4 v[60:63], v1, s[48:51], s14 offen nt
  v_add_u32 v1, s61, v1
  s_cbranch_scc1 L_a_121
  s_waitcnt vmcnt(4)
L_a_121:
  s_cbranch_vccnz L_b_122
  s_waitcnt vmcnt(5)
L_b_122:
  s_waitcnt vmcnt(7)
  buffer_load_dwordx4 v[64:67], v1, s[48:51], s14 offen nt
  v_add_u32 v1, s61, v1
  s_cmp_ge_i32 s60, 8
  s_cselect_b64 vcc, -1, 0
  s_cmp_ge_i32 s60, -8
  s_cbranch_scc1 L_a_123
  s_waitcnt vmcnt(4)
L_a_123:
  s_cbranch_vccnz L_b_124
  s_waitcnt vmcnt(5)
L_b_124:
  s_waitcnt vmcnt(7)
  buffer_load_dwordx4 v[68:71], v1, s[48:51], s14 offen nt
  v_add_u32 v1, s61, v1
  s_cbranch_scc1 L_a_125
  s_waitcnt vmcnt(3)
L_a_125:
  s_cbranch_vccnz L_b_126
  s_waitcnt vmcnt(5)
L_b_126:
  s_waitcnt vmcnt(7)
  buffer_load_dwordx4 v[72:75], v1, s[48:51], s14 offen nt
  v_add_u32 v1, s61, v1
  s_cbranch_scc1 L_a_127
  s_waitcnt vmcnt(3)
L_a_127:
  s_cbranch_vccnz L_b_128
  s_waitcnt vmcnt(4)
L_b_128:
  s_waitcnt vmcnt(7)
  buffer_load_dwordx4 v[76:79], v1, s[48:51], s14 offen nt
  v_add_u32 v1, s61, v1
  s_cmp_ge_i32 s60, 10
  s_cselect_b64 vcc, -1, 0
  s_cmp_ge_i32 s60, -10
  s_cbranch_scc1 L_a_129
  s_waitcnt vmcnt(3)
L_a_129:
  s_cbranch_vccnz L_b_130
  s_waitcnt vmcnt(4)
L_b_130:
  s_waitcnt vmcnt(7)
  buffer_load_dwordx4 v[80:83], v1, s[48:51], s14 offen nt
  v_add_u32 v1, s61, v1
  s_cbranch_scc1 L_a_131
  s_waitcnt vmcnt(3)
L_a_131:
  s_cbranch_vccnz L_b_132
  s_waitcnt vmcnt(4)
L_b_132:
  s_waitcnt vmcnt(6)
  buffer_load_dwordx4 v[84:87], v1, s[48:51], s14 offen nt
  v_add_u32 v1, s61, v1
  s_cbranch_scc1 L_a_133
  s_waitcnt vmcnt(3)
L_a_133:
  s_cbranch_vccnz L_b_134
  s_waitcnt vmcnt(4)
L_b_134:
  s_waitcnt vmcnt(6)
  buffer_load_dwordx4 v[88:91], v1, s[48:51], s14 offen nt
  v_add_u32 v1, s61, v1
  s_cmp_ge_i32 s60, 12
  s_cselect_b64 vcc, -1, 0
  s_cmp_ge_i32 s60, -12
  s_cbranch_scc1 L_a_135
  s_waitcnt vmcnt(3)
L_a_135:
  s_cbranch_vccnz L_b_136
  s_waitcnt vmcnt(4)
L_b_136:
  s_waitcnt vmcnt(6)
  buffer_load_dwordx4 v[92:95], v1, s[48:51], s14 offen nt
  v_add_u32 v1, s61, v1
  s_cbranch_scc1 L_a_137
  s_waitcnt vmcnt(3)
L_a_137:
  s_cbranch_vccnz L_b_138
  s_waitcnt vmcnt(4)
L_b_138:
  s_waitcnt vmcnt(6)
  buffer_load_dwordx4 v[96:99], v1, s[48:51], s14 offen nt
  v_add_u32 v1, s61, v1
  s_cbranch_scc1 L_a_139
  s_waitcnt vmcnt(3)
L_a_139:
  s_cbranch_vccnz L_b_140
  s_waitcnt vmcnt(4)
L_b_140:
  s_waitcnt vmcnt(6)
  buffer_load_dwordx4 v[132:135], v1, s[48:51], s14 offen nt
  v_add_u32 v1, s61, v1
  s_cmp_ge_i32 s60, 14
  s_cselect_b64 vcc, -1, 0
  s_cmp_ge_i32 s60, -14
  s_cbranch_scc1 L_a_141
  s_waitcnt vmcnt(3)
L_a_141:
  s_cbranch_vccnz L_b_142
  s_waitcnt vmcnt(4)
L_b_142:
  s_waitcnt vmcnt(6)
  buffer_load_dwordx4 v[152:155], v1, s[48:51], s14 offen nt
  v_add_u32 v1, s61, v1
  s_cbranch_scc1 L_a_143
  s_waitcnt vmcnt(3)
L_a_143:
  s_cbranch_vccnz L_b_144
  s_waitcnt vmcnt(4)
L_b_144:
  s_waitcnt vmcnt(6)
  buffer_load_dwordx4 v[172:175], v1, s[48:51], s14 offen nt
  v_add_u32 v1, s61, v1
  s_cbranch_scc1 L_a_145
  s_waitcnt vmcnt(3)
L_a_145:
  s_cbranch_vccnz L_b_146
  s_waitcnt vmcnt(4)
L_b_146:
  s_waitcnt vmcnt(6)
  buffer_load_dwordx4 v[192:195], v1, s[48:51], s14 offen nt
  v_add_u32 v1, s61, v1
  s_cmp_ge_i32 s60, 16
  s_cselect_b64 vcc, -1, 0
  s_cmp_ge_i32 s60, -16
  s_cbranch_scc1 L_a_147
  s_waitcnt vmcnt(3)
L_a_147:
  s_cbranch_vccnz L_b_148
  s_waitcnt vmcnt(4)
L_b_148:
  s_waitcnt vmcnt(6)
  buffer_load_dwordx4 v[212:215], v1, s[48:51], s14 offen nt
  v_add_u32 v1, s61, v1
  s_cbranch_scc1 L_a_149
  s_waitcnt vmcnt(3)
L_a_149:
  s_cbranch_vccnz L_b_150
  s_waitcnt vmcnt(4)
L_b_150:
  s_waitcnt vmcnt(6)
  buffer_load_dwordx4 v[232:235], v1, s[48:51], s14 offen nt
  v_add_u32 v1, s61, v1
  v_mov_b32 v47, 1
  s_mov_b64 exec, 1
  buffer_atomic_add v47, v45, s[52:55], s68 offen offset:512 sc0
  s_mov_b64 exec, -1
  s_cbranch_scc1 L_a_151
  s_waitcnt vmcnt(4)
L_a_151:
  s_cbranch_vccnz L_b_152
  s_waitcnt vmcnt(5)
L_b_152:
  s_waitcnt vmcnt(7)
  buffer_load_dwordx4 v[252:255], v1, s[48:51], s14 offen nt
  v_add_u32 v1, s61, v1
  buffer_load_dwordx4 v[20:23], v3, s[52:55], s13 offen sc1
  s_cmp_ge_i32 s60, 18
  s_cselect_b64 vcc, -1, 0
  s_cmp_ge_i32 s60, -18
  s_cbranch_scc1 L_a_153
  s_waitcnt vmcnt(5)
L_a_153:
  s_cbranch_vccnz L_b_154
  s_waitcnt vmcnt(6)
L_b_154:
  s_waitcnt vmcnt(8)
  buffer_load_dwordx4 v[100:103], v1, s[48:51], s14 offen nt
  v_add_u32 v1, s61, v1
  s_cbranch_scc1 L_a_155
  s_waitcnt vmcnt(5)
L_a_155:
  s_cbranch_vccnz L_b_156
  s_waitcnt vmcnt(6)
L_b_156:
  s_waitcnt vmcnt(8)
  buffer_load_dwordx4 v[104:107], v1, s[48:51], s14 offen nt
  v_add_u32 v1, s61, v1
  s_cbranch_scc1 L_a_157
  s_waitcnt vmcnt(5)
L_a_157:
  s_cbranch_vccnz L_b_158
  s_waitcnt vmcnt(6)
L_b_158:
  s_waitcnt vmcnt(8)
  buffer_load_dwordx4 v[108:111], v1, s[48:51], s14 offen nt
  v_add_u32 v1, s61, v1
  s_cmp_ge_i32 s60, 20
  s_cselect_b64 vcc, -1, 0
  s_cmp_ge_i32 s60, -20
  s_cbranch_scc1 L_a_159
  s_waitcnt vmcnt(4)
L_a_159:
  s_cbranch_vccnz L_b_160
  s_waitcnt vmcnt(6)
L_b_160:
  s_waitcnt vmcnt(8)
  buffer_load_dwordx4 v[112:115], v1, s[48:51], s14 offen nt
  v_add_u32 v1, s61, v1
  s_cbranch_scc1 L_a_161
  s_waitcnt vmcnt(3)
L_a_161:
  s_cbranch_vccnz L_b_162
  s_waitcnt vmcnt(5)
L_b_162:
  s_waitcnt vmcnt(8)
  buffer_load_dwordx4 v[116:119], v1, s[48:51], s14 offen nt
  v_add_u32 v1, s61, v1
  s_cbranch_scc1 L_a_163
  s_waitcnt vmcnt(3)
L_a_163:
  s_cbranch_vccnz L_b_164
  s_waitcnt vmcnt(4)
L_b_164:
  s_waitcnt vmcnt(8)
  buffer_load_dwordx4 v[120:123], v1, s[48:51], s14 offen nt
  v_add_u32 v1, s61, v1
  s_cmp_ge_i32 s60, 22
  s_cselect_b64 vcc, -1, 0
  s_cmp_ge_i32 s60, -22
  s_cbranch_scc1 L_a_165
  s_waitcnt vmcnt(3)
L_a_165:
  s_cbranch_vccnz L_b_166
  s_waitcnt vmcnt(4)
L_b_166:
  s_waitcnt vmcnt(7)
  buffer_load_dwordx4 v[124:127], v1, s[48:51], s14 offen nt
  v_add_u32 v1, s61, v1
  v_subrev_u32 v47, 32, v47
  s_mov_b64 exec, 1
  ds_write_b32 v44, v47 offset:20
  s_mov_b64 exec, -1
  s_cbranch_scc1 L_a_167
  s_waitcnt vmcnt(3)
L_a_167:
  s_cbranch_vccnz L_b_168
  s_waitcnt vmcnt(4)
L_b_168:
  s_waitcnt vmcnt(6)
  buffer_load_dwordx4 v[128:131], v1, s[48:51], s14 offen nt
  v_add_u32 v1, s61, v1
  ds_read_b32 v46, v2 offset:20
  s_branch L_spc_171
L_sp_169:
  buffer_load_dwordx4 v[20:23], v3, s[52:55], s13 offen sc1
  s_waitcnt vmcnt(0)
L_spc_171:
  v_cmp_ne_u32 s[10:11], s7, v21
  v_cmp_ne_u32 vcc, s7, v23
  s_or_b64 s[10:11], s[10:11], vcc
  s_cbranch_scc0 L_spd_170
  s_sleep 2
  s_add_u32 s8, s8, 1
  s_cmp_lt_u32 s8, 262144
  s_cbranch_scc1 L_sp_169
L_spd_170:
  v_max_f32_dpp v24, v20, v20 quad_perm:[1,0,3,2] row_mask:0xf bank_mask:0xf
  s_nop 1
  v_max_f32_dpp v24, v24, v24 quad_perm:[2,3,0,1] row_mask:0xf bank_mask:0xf
  s_nop 1
  v_max_f32_dpp v24, v24, v24 row_half_mirror row_mask:0xf bank_mask:0xf
  v_sub_f32 v20, v20, v24
  v_mul_f32 v20, s71, v20
  v_exp_f32 v20, v20
  v_sub_f32 v12, v12, v24
  v_mul_f32 v12, s71, v12
  v_sub_f32 v13, v13, v24
  v_mul_f32 v13, s71, v13
  v_sub_f32 v14, v14, v24
  v_mul_f32 v14, s71, v14
  v_sub_f32 v15, v15, v24
  v_mul_f32 v15, s71, v15
  v_sub_f32 v16, v16, v24
  v_mul_f32 v16, s71, v16
  v_sub_f32 v17, v17, v24
  v_mul_f32 v17, s71, v17
  v_sub_f32 v18, v18, v24
  v_mul_f32 v18, s71, v18
  v_sub_f32 v19, v19, v24
  v_mul_f32 v19, s71, v19
  v_mul_f32 v25, v20, v22
  v_exp_f32 v12, v12
  v_exp_f32 v13, v13
  v_add_f32_dpp v25, v25, v25 quad_perm:[1,0,3,2] row_mask:0xf bank_mask:0xf
  v_exp_f32 v14, v14
  v_exp_f32 v15, v15
  v_add_f32_dpp v25, v25, v25 quad_perm:[2,3,0,1] row_mask:0xf bank_mask:0xf
  v_exp_f32 v16, v16
  v_exp_f32 v17, v17
  v_add_f32_dpp v25, v25, v25 row_half_mirror row_mask:0xf bank_mask:0xf
  v_exp_f32 v18, v18
  v_exp_f32 v19, v19
  v_rcp_f32 v25, v25
  s_waitcnt lgkmcnt(0)
  v_readfirstlane_b32 s60, v46
  s_cmp_ge_i32 s60, 5
  s_cselect_b64 vcc, -1, 0
  s_cmp_ge_i32 s60, -5
  s_cbranch_scc1 L_a_172
  s_waitcnt vmcnt(3)
L_a_172:
  s_cbranch_vccnz L_b_173
  s_waitcnt vmcnt(4)
L_b_173:
  s_waitcnt vmcnt(6)
  buffer_load_dwordx4 v[136:139], v1, s[48:51], s14 offen nt
  v_add_u32 v1, s61, v1
  v_mul_f32 v12, v12, v25
  v_mul_f32 v13, v13, v25
  v_mul_f32 v14, v14, v25
  v_mul_f32 v15, v15, v25
  v_mul_f32 v16, v16, v25
  v_mul_f32 v17, v17, v25
  v_mul_f32 v18, v18, v25
  v_mul_f32 v19, v19, v25
  v_cvt_pk_bf16_f32 v12, v12, v12
  v_cvt_pk_bf16_f32 v13, v13, v13
  v_cvt_pk_bf16_f32 v14, v14, v14
  v_cvt_pk_bf16_f32 v15, v15, v15
  v_cvt_pk_bf16_f32 v16, v16, v16
  v_cvt_pk_bf16_f32 v17, v17, v17
  v_cvt_pk_bf16_f32 v18, v18, v18
  v_cvt_pk_bf16_f32 v19, v19, v19
  v_bfe_u32 v40, v0, 3, 1
  s_lshl_b32 s10, s9, 1
  v_add_u32 v24, s10, v40
  v_mul_u32_u24 v24, 272, v24
  v_lshrrev_b32 v41, 4, v0
  v_subrev_u32 v41, s5, v41
  v_and_b32 v41, 3, v41
  v_lshl_add_u32 v24, v41, 6, v24
  v_and_b32 v41, 7, v0
  v_xor_b32 v41, s6, v41
  v_lshl_add_u32 v24, v41, 3, v24
  v_sub_u32 v25, 0, v40
  v_and_b32 v25, s70, v25
  s_mov_b32 s69, 0x07060302
  v_and_b32_dpp v28, v12, v4 row_newbcast:0 row_mask:0xf bank_mask:0xf
  v_and_b32_dpp v29, v12, v5 row_newbcast:0 row_mask:0xf bank_mask:0xf
  v_and_b32_dpp v30, v12, v6 row_newbcast:0 row_mask:0xf bank_mask:0xf
  v_and_b32_dpp v31, v12, v7 row_newbcast:0 row_mask:0xf bank_mask:0xf
  v_and_b32_dpp v32, v12, v4 row_newbcast:8 row_mask:0xf bank_mask:0xf
  v_and_b32_dpp v33, v12, v5 row_newbcast:8 row_mask:0xf bank_mask:0xf
  v_and_b32_dpp v34, v12, v6 row_newbcast:8 row_mask:0xf bank_mask:0xf
  v_and_b32_dpp v35, v12, v7 row_newbcast:8 row_mask:0xf bank_mask:0xf
  v_mfma_f32_16x16x32_bf16 v[36:39], v[216:219], v[28:31], 0
  v_and_b32_dpp v28, v12, v4 row_newbcast:4 row_mask:0xf bank_mask:0xf
  v_and_b32_dpp v29, v12, v5 row_newbcast:4 row_mask:0xf bank_mask:0xf
  v_and_b32_dpp v30, v12, v6 row_newbcast:4 row_mask:0xf bank_mask:0xf
  v_and_b32_dpp v31, v12, v7 row_newbcast:4 row_mask:0xf bank_mask:0xf
  v_mfma_f32_16x16x32_bf16 v[36:39], v[220:223], v[32:35], v[36:39]
  v_and_b32_dpp v32, v12, v4 row_newbcast:12 row_mask:0xf bank_mask:0xf
  v_and_b32_dpp v33, v12, v5 row_newbcast:12 row_mask:0xf bank_mask:0xf
  v_and_b32_dpp v34, v12, v6 row_newbcast:12 row_mask:0xf bank_mask:0xf
  v_and_b32_dpp v35, v12, v7 row_newbcast:12 row_mask:0xf bank_mask:0xf
  v_mfma_f32_16x16x32_bf16 v[36:39], v[224:227], v[28:31], v[36:39]
  v_and_b32_dpp v28, v12, v4 row_newbcast:1 row_mask:0xf bank_mask:0xf
  v_and_b32_dpp v29, v12, v5 row_newbcast:1 row_mask:0xf bank_mask:0xf
  v_and_b32_dpp v30, v12, v6 row_newbcast:1 row_mask:0xf bank_mask:0xf
  v_and_b32_dpp v31, v12, v7 row_newbcast:1 row_mask:0xf bank_mask:0xf
  v_mfma_f32_16x16x32_bf16 v[36:39], v[228:231], v[32:35], v[36:39]
  s_cmp_ge_i32 s60, 5
  s_cselect_b64 vcc, -1, 0
  s_cmp_ge_i32 s60, -5
  s_cbranch_scc1 L_a_174
  s_waitcnt vmcnt(3)
L_a_174:
  s_cbranch_vccnz L_b_175
  s_waitcnt vmcnt(4)
L_b_175:
  s_waitcnt vmcnt(6)
  buffer_load_dwordx4 v[140:143], v1, s[48:51], s14 offen nt
  v_add_u32 v1, s61, v1
  v_and_b32_dpp v32, v12, v4 row_newbcast:9 row_mask:0xf bank_mask:0xf
  v_and_b32_dpp v33, v12, v5 row_newbcast:9 row_mask:0xf bank_mask:0xf
  v_and_b32_dpp v34, v12, v6 row_newbcast:9 row_mask:0xf bank_mask:0xf
  v_and_b32_dpp v35, v12, v7 row_newbcast:9 row_mask:0xf bank_mask:0xf
  v_mfma_f32_16x16x32_bf16 v[36:39], v[236:239], v[28:31], v[36:39]
  v_and_b32_dpp v28, v12, v4 row_newbcast:5 row_mask:0xf bank_mask:0xf
  v_and_b32_dpp v29, v12, v5 row_newbcast:5 row_mask:0xf bank_mask:0xf
  v_and_b32_dpp v30, v12, v6 row_newbcast:5 row_mask:0xf bank_mask:0xf
  v_and_b32_dpp v31, v12, v7 row_newbcast:5 row_mask:0xf bank_mask:0xf
  v_mfma_f32_16x16x32_bf16 v[36:39], v[240:243], v[32:35], v[36:39]
  v_and_b32_dpp v32, v12, v4 row_newbcast:13 row_mask:0xf bank_mask:0xf
  v_and_b32_dpp v33, v12, v5 row_newbcast:13 row_mask:0xf bank_mask:0xf
  v_and_b32_dpp v34, v12, v6 row_newbcast:13 row_mask:0xf bank_mask:0xf
  v_and_b32_dpp v35, v12, v7 row_newbcast:13 row_mask:0xf bank_mask:0xf
  v_mfma_f32_16x16x32_bf16 v[36:39], v[244:247], v[28:31], v[36:39]
  v_and_b32_dpp v28, v12, v4 row_newbcast:2 row_mask:0xf bank_mask:0xf
  v_and_b32_dpp v29, v12, v5 row_newbcast:2 row_mask:0xf bank_mask:0xf
  v_and_b32_dpp v30, v12, v6 row_newbcast:2 row_mask:0xf bank_mask:0xf
  v_and_b32_dpp v31, v12, v7 row_newbcast:2 row_mask:0xf bank_mask:0xf
  v_mfma_f32_16x16x32_bf16 v[36:39], v[248:251], v[32:35], v[36:39]
  s_cbranch_scc1 L_a_176
  s_waitcnt vmcnt(3)
L_a_176:
  s_cbranch_vccnz L_b_177
  s_waitcnt vmcnt(4)
L_b_177:
  s_waitcnt vmcnt(6)
  buffer_load_dwordx4 v[144:147], v1, s[48:51], s14 offen nt
  v_add_u32 v1, s61, v1
  ds_read_b32 v46, v2 offset:20
  v_and_b32_dpp v32, v12, v4 row_newbcast:10 row_mask:0xf bank_mask:0xf
  v_and_b32_dpp v33, v12, v5 row_newbcast:10 row_mask:0xf bank_mask:0xf
  v_and_b32_dpp v34, v12, v6 row_newbcast:10 row_mask:0xf bank_mask:0xf
  v_and_b32_dpp v35, v12, v7 row_newbcast:10 row_mask:0xf bank_mask:0xf
  v_mfma_f32_16x16x32_bf16 v[36:39], v[48:51], v[28:31], v[36:39]
  v_and_b32_dpp v28, v12, v4 row_newbcast:6 row_mask:0xf bank_mask:0xf
  v_and_b32_dpp v29, v12, v5 row_newbcast:6 row_mask:0xf bank_mask:0xf
  v_and_b32_dpp v30, v12, v6 row_newbcast:6 row_mask:0xf bank_mask:0xf
  v_and_b32_dpp v31, v12, v7 row_newbcast:6 row_mask:0xf bank_mask:0xf
  v_mfma_f32_16x16x32_bf16 v[36:39], v[52:55], v[32:35], v[36:39]
  v_and_b32_dpp v32, v12, v4 row_newbcast:14 row_mask:0xf bank_mask:0xf
  v_and_b32_dpp v33, v12, v5 row_newbcast:14 row_mask:0xf bank_mask:0xf
  v_and_b32_dpp v34, v12, v6 row_newbcast:14 row_mask:0xf bank_mask:0xf
  v_and_b32_dpp v35, v12, v7 row_newbcast:14 row_mask:0xf bank_mask:0xf
  v_mfma_f32_16x16x32_bf16 v[36:39], v[56:59], v[28:31], v[36:39]
  v_and_b32_dpp v28, v12, v4 row_newbcast:3 row_mask:0xf bank_mask:0xf
  v_and_b32_dpp v29, v12, v5 row_newbcast:3 row_mask:0xf bank_mask:0xf
  v_and_b32_dpp v30, v12, v6 row_newbcast:3 row_mask:0xf bank_mask:0xf
  v_and_b32_dpp v31, v12, v7 row_newbcast:3 row_mask:0xf bank_mask:0xf
  v_mfma_f32_16x16x32_bf16 v[36:39], v[60:63], v[32:35], v[36:39]
  s_waitcnt lgkmcnt(0)
  v_readfirstlane_b32 s60, v46
  s_cmp_ge_i32 s60, 5
  s_cselect_b64 vcc, -1, 0
  s_cmp_ge_i32 s60, -5
  s_cbranch_scc1 L_a_178
  s_waitcnt vmcnt(3)
L_a_178:
  s_cbranch_vccnz L_b_179
  s_waitcnt vmcnt(4)
L_b_179:
  s_waitcnt vmcnt(6)
  buffer_load_dwordx4 v[148:151], v1, s[48:51], s14 offen nt
  v_add_u32 v1, s61, v1
  v_and_b32_dpp v32, v12, v4 row_newbcast:11 row_mask:0xf bank_mask:0xf
  v_and_b32_dpp v33, v12, v5 row_newbcast:11 row_mask:0xf bank_mask:0xf
  v_and_b32_dpp v34, v12, v6 row_newbcast:11 row_mask:0xf bank_mask:0xf
  v_and_b32_dpp v35, v12, v7 row_newbcast:11 row_mask:0xf bank_mask:0xf
  v_mfma_f32_16x16x32_bf16 v[36:39], v[64:67], v[28:31], v[36:39]
  v_and_b32_dpp v28, v12, v4 row_newbcast:7 row_mask:0xf bank_mask:0xf
  v_and_b32_dpp v29, v12, v5 row_newbcast:7 row_mask:0xf bank_mask:0xf
  v_and_b32_dpp v30, v12, v6 row_newbcast:7 row_mask:0xf bank_mask:0xf
  v_and_b32_dpp v31, v12, v7 row_newbcast:7 row_mask:0xf bank_mask:0xf
  v_mfma_f32_16x16x32_bf16 v[36:39], v[68:71], v[32:35], v[36:39]
  v_and_b32_dpp v32, v12, v4 row_newbcast:15 row_mask:0xf bank_mask:0xf
  v_and_b32_dpp v33, v12, v5 row_newbcast:15 row_mask:0xf bank_mask:0xf
  v_and_b32_dpp v34, v12, v6 row_newbcast:15 row_mask:0xf bank_mask:0xf
  v_and_b32_dpp v35, v12, v7 row_newbcast:15 row_mask:0xf bank_mask:0xf
  v_mfma_f32_16x16x32_bf16 v[36:39], v[72:75], v[28:31], v[36:39]
  v_and_b32_dpp v28, v13, v4 row_newbcast:0 row_mask:0xf bank_mask:0xf
  v_and_b32_dpp v29, v13, v5 row_newbcast:0 row_mask:0xf bank_mask:0xf
  v_and_b32_dpp v30, v13, v6 row_newbcast:0 row_mask:0xf bank_mask:0xf
  v_and_b32_dpp v31, v13, v7 row_newbcast:0 row_mask:0xf bank_mask:0xf
  v_mfma_f32_16x16x32_bf16 v[36:39], v[76:79], v[32:35], v[36:39]
  s_cbranch_scc1 L_a_180
  s_waitcnt vmcnt(3)
L_a_180:
  s_cbranch_vccnz L_b_181
  s_waitcnt vmcnt(4)
L_b_181:
  s_waitcnt vmcnt(6)
  buffer_load_dwordx4 v[156:159], v1, s[48:51], s14 offen nt
  v_add_u32 v1, s61, v1
  v_and_b32_dpp v32, v13, v4 row_newbcast:8 row_mask:0xf bank_mask:0xf
  v_and_b32_dpp v33, v13, v5 row_newbcast:8 row_mask:0xf bank_mask:0xf
  v_and_b32_dpp v34, v13, v6 row_newbcast:8 row_mask:0xf bank_mask:0xf
  v_and_b32_dpp v35, v13, v7 row_newbcast:8 row_mask:0xf bank_mask:0xf
  v_mfma_f32_16x16x32_bf16 v[36:39], v[80:83], v[28:31], v[36:39]
  v_and_b32_dpp v28, v13, v4 row_newbcast:4 row_mask:0xf bank_mask:0xf
  v_and_b32_dpp v29, v13, v5 row_newbcast:4 row_mask:0xf bank_mask:0xf
  v_and_b32_dpp v30, v13, v6 row_newbcast:4 row_mask:0xf bank_mask:0xf
  v_and_b32_dpp v31, v13, v7 row_newbcast:4 row_mask:0xf bank_mask:0xf
  v_mfma_f32_16x16x32_bf16 v[36:39], v[84:87], v[32:35], v[36:39]
  v_and_b32_dpp v32, v13, v4 row_newbcast:12 row_mask:0xf bank_mask:0xf
  v_and_b32_dpp v33, v13, v5 row_newbcast:12 row_mask:0xf bank_mask:0xf
  v_and_b32_dpp v34, v13, v6 row_newbcast:12 row_mask:0xf bank_mask:0xf
  v_and_b32_dpp v35, v13, v7 row_newbcast:12 row_mask:0xf bank_mask:0xf
  v_mfma_f32_16x16x32_bf16 v[36:39], v[88:91], v[28:31], v[36:39]
  v_and_b32_dpp v28, v13, v4 row_newbcast:1 row_mask:0xf bank_mask:0xf
  v_and_b32_dpp v29, v13, v5 row_newbcast:1 row_mask:0xf bank_mask:0xf
  v_and_b32_dpp v30, v13, v6 row_newbcast:1 row_mask:0xf bank_mask:0xf
  v_and_b32_dpp v31, v13, v7 row_newbcast:1 row_mask:0xf bank_mask:0xf
  v_mfma_f32_16x16x32_bf16 v[36:39], v[92:95], v[32:35], v[36:39]
  s_cbranch_scc1 L_a_182
  s_waitcnt vmcnt(3)
L_a_182:
  s_cbranch_vccnz L_b_183
  s_waitcnt vmcnt(4)
L_b_183:
  s_waitcnt vmcnt(6)
  buffer_load_dwordx4 v[160:163], v1, s[48:51], s14 offen nt
  v_add_u32 v1, s61, v1
  v_and_b32_dpp v32, v13, v4 row_newbcast:9 row_mask:0xf bank_mask:0xf
  v_and_b32_dpp v33, v13, v5 row_newbcast:9 row_mask:0xf bank_mask:0xf
  v_and_b32_dpp v34, v13, v6 row_newbcast:9 row_mask:0xf bank_mask:0xf
  v_and_b32_dpp v35, v13, v7 row_newbcast:9 row_mask:0xf bank_mask:0xf
  v_mfma_f32_16x16x32_bf16 v[36:39], v[96:99], v[28:31], v[36:39]
  v_and_b32_dpp v28, v13, v4 row_newbcast:5 row_mask:0xf bank_mask:0xf
  v_and_b32_dpp v29, v13, v5 row_newbcast:5 row_mask:0xf bank_mask:0xf
  v_and_b32_dpp v30, v13, v6 row_newbcast:5 row_mask:0xf bank_mask:0xf
  v_and_b32_dpp v31, v13, v7 row_newbcast:5 row_mask:0xf bank_mask:0xf
  v_mfma_f32_16x16x32_bf16 v[36:39], v[132:135], v[32:35], v[36:39]
  v_and_b32_dpp v32, v13, v4 row_newbcast:13 row_mask:0xf bank_mask:0xf
  v_and_b32_dpp v33, v13, v5 row_newbcast:13 row_mask:0xf bank_mask:0xf
  v_and_b32_dpp v34, v13, v6 row_newbcast:13 row_mask:0xf bank_mask:0xf
  v_and_b32_dpp v35, v13, v7 row_newbcast:13 row_mask:0xf bank_mask:0xf
  v_mfma_f32_16x16x32_bf16 v[36:39], v[152:155], v[28:31], v[36:39]
  v_and_b32_dpp v28, v13, v4 row_newbcast:2 row_mask:0xf bank_mask:0xf
  v_and_b32_dpp v29, v13, v5 row_newbcast:2 row_mask:0xf bank_mask:0xf
  v_and_b32_dpp v30, v13, v6 row_newbcast:2 row_mask:0xf bank_mask:0xf
  v_and_b32_dpp v31, v13, v7 row_newbcast:2 row_mask:0xf bank_mask:0xf
  v_mfma_f32_16x16x32_bf16 v[36:39], v[172:175], v[32:35], v[36:39]
  s_cbranch_scc1 L_a_184
  s_waitcnt vmcnt(3)
L_a_184:
  s_cbranch_vccnz L_b_185
  s_waitcnt vmcnt(4)
L_b_185:
  s_waitcnt vmcnt(6)
  buffer_load_dwordx4 v[164:167], v1, s[48:51], s14 offen nt
  v_add_u32 v1, s61, v1
  v_and_b32_dpp v32, v13, v4 row_newbcast:10 row_mask:0xf bank_mask:0xf
  v_and_b32_dpp v33, v13, v5 row_newbcast:10 row_mask:0xf bank_mask:0xf
  v_and_b32_dpp v34, v13, v6 row_newbcast:10 row_mask:0xf bank_mask:0xf
  v_and_b32_dpp v35, v13, v7 row_newbcast:10 row_mask:0xf bank_mask:0xf
  v_mfma_f32_16x16x32_bf16 v[36:39], v[192:195], v[28:31], v[36:39]
  v_and_b32_dpp v28, v13, v4 row_newbcast:6 row_mask:0xf bank_mask:0xf
  v_and_b32_dpp v29, v13, v5 row_newbcast:6 row_mask:0xf bank_mask:0xf
  v_and_b32_dpp v30, v13, v6 row_newbcast:6 row_mask:0xf bank_mask:0xf
  v_and_b32_dpp v31, v13, v7 row_newbcast:6 row_mask:0xf bank_mask:0xf
  v_mfma_f32_16x16x32_bf16 v[36:39], v[212:215], v[32:35], v[36:39]
  v_and_b32_dpp v32, v13, v4 row_newbcast:14 row_mask:0xf bank_mask:0xf
  v_and_b32_dpp v33, v13, v5 row_newbcast:14 row_mask:0xf bank_mask:0xf
  v_and_b32_dpp v34, v13, v6 row_newbcast:14 row_mask:0xf bank_mask:0xf
  v_and_b32_dpp v35, v13, v7 row_newbcast:14 row_mask:0xf bank_mask:0xf
  v_mfma_f32_16x16x32_bf16 v[36:39], v[232:235], v[28:31], v[36:39]
  v_and_b32_dpp v28, v13, v4 row_newbcast:3 row_mask:0xf bank_mask:0xf
  v_and_b32_dpp v29, v13, v5 row_newbcast:3 row_mask:0xf bank_mask:0xf
  v_and_b32_dpp v30, v13, v6 row_newbcast:3 row_mask:0xf bank_mask:0xf
  v_and_b32_dpp v31, v13, v7 row_newbcast:3 row_mask:0xf bank_mask:0xf
  v_mfma_f32_16x16x32_bf16 v[36:39], v[252:255], v[32:35], v[36:39]
  s_cbranch_scc1 L_a_186
  s_waitcnt vmcnt(3)
L_a_186:
  s_cbranch_vccnz L_b_187
  s_waitcnt vmcnt(4)
L_b_187:
  s_waitcnt vmcnt(6)
  buffer_load_dwordx4 v[168:171], v1, s[48:51], s14 offen nt
  v_add_u32 v1, s61, v1
  v_and_b32_dpp v32, v13, v4 row_newbcast:11 row_mask:0xf bank_mask:0xf
  v_and_b32_dpp v33, v13, v5 row_newbcast:11 row_mask:0xf bank_mask:0xf
  v_and_b32_dpp v34, v13, v6 row_newbcast:11 row_mask:0xf bank_mask:0xf
  v_and_b32_dpp v35, v13, v7 row_newbcast:11 row_mask:0xf bank_mask:0xf
  v_mfma_f32_16x16x32_bf16 v[36:39], v[100:103], v[28:31], v[36:39]
  v_and_b32_dpp v28, v13, v4 row_newbcast:7 row_mask:0xf bank_mask:0xf
  v_and_b32_dpp v29, v13, v5 row_newbcast:7 row_mask:0xf bank_mask:0xf
  v_and_b32_dpp v30, v13, v6 row_newbcast:7 row_mask:0xf bank_mask:0xf
  v_and_b32_dpp v31, v13, v7 row_newbcast:7 row_mask:0xf bank_mask:0xf
  v_mfma_f32_16x16x32_bf16 v[36:39], v[104:107], v[32:35], v[36:39]
  v_and_b32_dpp v32, v13, v4 row_newbcast:15 row_mask:0xf bank_mask:0xf
  v_and_b32_dpp v33, v13, v5 row_newbcast:15 row_mask:0xf bank_mask:0xf
  v_and_b32_dpp v34, v13, v6 row_newbcast:15 row_mask:0xf bank_mask:0xf
  v_and_b32_dpp v35, v13, v7 row_newbcast:15 row_mask:0xf bank_mask:0xf
  v_mfma_f32_16x16x32_bf16 v[36:39], v[108:111], v[28:31], v[36:39]
  v_and_b32_dpp v28, v14, v4 row_newbcast:0 row_mask:0xf bank_mask:0xf
  v_and_b32_dpp v29, v14, v5 row_newbcast:0 row_mask:0xf bank_mask:0xf
  v_and_b32_dpp v30, v14, v6 row_newbcast:0 row_mask:0xf bank_mask:0xf
  v_and_b32_dpp v31, v14, v7 row_newbcast:0 row_mask:0xf bank_mask:0xf
  v_mfma_f32_16x16x32_bf16 v[36:39], v[112:115], v[32:35], v[36:39]
  s_cbranch_scc1 L_a_188
  s_waitcnt vmcnt(3)
L_a_188:
  s_cbranch_vccnz L_b_189
  s_waitcnt vmcnt(4)
L_b_189:
  s_waitcnt vmcnt(6)
  buffer_load_dwordx4 v[176:179], v1, s[48:51], s14 offen nt
  v_add_u32 v1, s61, v1
  v_and_b32_dpp v32, v14, v4 row_newbcast:8 row_mask:0xf bank_mask:0xf
  v_and_b32_dpp v33, v14, v5 row_newbcast:8 row_mask:0xf bank_mask:0xf
  v_and_b32_dpp v34, v14, v6 row_newbcast:8 row_mask:0xf bank_mask:0xf
  v_and_b32_dpp v35, v14, v7 row_newbcast:8 row_mask:0xf bank_mask:0xf
  v_mfma_f32_16x16x32_bf16 v[36:39], v[116:119], v[28:31], v[36:39]
  v_and_b32_dpp v28, v14, v4 row_newbcast:4 row_mask:0xf bank_mask:0xf
  v_and_b32_dpp v29, v14, v5 row_newbcast:4 row_mask:0xf bank_mask:0xf
  v_and_b32_dpp v30, v14, v6 row_newbcast:4 row_mask:0xf bank_mask:0xf
  v_and_b32_dpp v31, v14, v7 row_newbcast:4 row_mask:0xf bank_mask:0xf
  v_mfma_f32_16x16x32_bf16 v[36:39], v[120:123], v[32:35], v[36:39]
  v_and_b32_dpp v32, v14, v4 row_newbcast:12 row_mask:0xf bank_mask:0xf
  v_and_b32_dpp v33, v14, v5 row_newbcast:12 row_mask:0xf bank_mask:0xf
  v_and_b32_dpp v34, v14, v6 row_newbcast:12 row_mask:0xf bank_mask:0xf
  v_and_b32_dpp v35, v14, v7 row_newbcast:12 row_mask:0xf bank_mask:0xf
  v_mfma_f32_16x16x32_bf16 v[36:39], v[124:127], v[28:31], v[36:39]
  v_and_b32_dpp v28, v14, v4 row_newbcast:1 row_mask:0xf bank_mask:0xf
  v_and_b32_dpp v29, v14, v5 row_newbcast:1 row_mask:0xf bank_mask:0xf
  v_and_b32_dpp v30, v14, v6 row_newbcast:1 row_mask:0xf bank_mask:0xf
  v_and_b32_dpp v31, v14, v7 row_newbcast:1 row_mask:0xf bank_mask:0xf
  v_mfma_f32_16x16x32_bf16 v[36:39], v[128:131], v[32:35], v[36:39]
  s_cmp_ge_i32 s60, 8
  s_cselect_b64 vcc, -1, 0
  s_cmp_ge_i32 s60, -8
  s_cbranch_scc1 L_a_190
  s_waitcnt vmcnt(3)
L_a_190:
  s_cbranch_vccnz L_b_191
  s_waitcnt vmcnt(4)
L_b_191:
  s_waitcnt vmcnt(6)
  buffer_load_dwordx4 v[180:183], v1, s[48:51], s14 offen nt
  v_add_u32 v1, s61, v1
  v_and_b32_dpp v32, v14, v4 row_newbcast:9 row_mask:0xf bank_mask:0xf
  v_and_b32_dpp v33, v14, v5 row_newbcast:9 row_mask:0xf bank_mask:0xf
  v_and_b32_dpp v34, v14, v6 row_newbcast:9 row_mask:0xf bank_mask:0xf
  v_and_b32_dpp v35, v14, v7 row_newbcast:9 row_mask:0xf bank_mask:0xf
  v_mfma_f32_16x16x32_bf16 v[36:39], v[136:139], v[28:31], v[36:39]
  v_and_b32_dpp v28, v14, v4 row_newbcast:5 row_mask:0xf bank_mask:0xf
  v_and_b32_dpp v29, v14, v5 row_newbcast:5 row_mask:0xf bank_mask:0xf
  v_and_b32_dpp v30, v14, v6 row_newbcast:5 row_mask:0xf bank_mask:0xf
  v_and_b32_dpp v31, v14, v7 row_newbcast:5 row_mask:0xf bank_mask:0xf
  v_mfma_f32_16x16x32_bf16 v[36:39], v[140:143], v[32:35], v[36:39]
  v_and_b32_dpp v32, v14, v4 row_newbcast:13 row_mask:0xf bank_mask:0xf
  v_and_b32_dpp v33, v14, v5 row_newbcast:13 row_mask:0xf bank_mask:0xf
  v_and_b32_dpp v34, v14, v6 row_newbcast:13 row_mask:0xf bank_mask:0xf
  v_and_b32_dpp v35, v14, v7 row_newbcast:13 row_mask:0xf bank_mask:0xf
  v_mfma_f32_16x16x32_bf16 v[36:39], v[144:147], v[28:31], v[36:39]
  s_cbranch_scc1 L_a_192
  s_waitcnt vmcnt(3)
L_a_192:
  s_cbranch_vccnz L_b_193
  s_waitcnt vmcnt(4)
L_b_193:
  s_waitcnt vmcnt(6)
  buffer_load_dwordx4 v[184:187], v1, s[48:51], s14 offen nt
  v_add_u32 v1, s61, v1
  v_and_b32_dpp v28, v14, v4 row_newbcast:2 row_mask:0xf bank_mask:0xf
  v_and_b32_dpp v29, v14, v5 row_newbcast:2 row_mask:0xf bank_mask:0xf
  v_and_b32_dpp v30, v14, v6 row_newbcast:2 row_mask:0xf bank_mask:0xf
  v_and_b32_dpp v31, v14, v7 row_newbcast:2 row_mask:0xf bank_mask:0xf
  v_mfma_f32_16x16x32_bf16 v[36:39], v[148:151], v[32:35], v[36:39]
  s_cbranch_scc1 L_a_194
  s_waitcnt vmcnt(3)
L_a_194:
  s_cbranch_vccnz L_b_195
  s_waitcnt vmcnt(4)
L_b_195:
  s_waitcnt vmcnt(6)
  buffer_load_dwordx4 v[188:191], v1, s[48:51], s14 offen nt
  v_add_u32 v1, s61, v1
  v_and_b32_dpp v32, v14, v4 row_newbcast:10 row_mask:0xf bank_mask:0xf
  v_and_b32_dpp v33, v14, v5 row_newbcast:10 row_mask:0xf bank_mask:0xf
  v_and_b32_dpp v34, v14, v6 row_newbcast:10 row_mask:0xf bank_mask:0xf
  v_and_b32_dpp v35, v14, v7 row_newbcast:10 row_mask:0xf bank_mask:0xf
  v_mfma_f32_16x16x32_bf16 v[36:39], v[156:159], v[28:31], v[36:39]
  s_cmp_ge_i32 s60, 10
  s_cselect_b64 vcc, -1, 0
  s_cmp_ge_i32 s60, -10
  s_cbranch_scc1 L_a_196
  s_waitcnt vmcnt(3)
L_a_196:
  s_cbranch_vccnz L_b_197
  s_waitcnt vmcnt(4)
L_b_197:
  s_waitcnt vmcnt(6)
  buffer_load_dwordx4 v[196:199], v1, s[48:51], s14 offen nt
  v_add_u32 v1, s61, v1
  v_and_b32_dpp v28, v14, v4 row_newbcast:6 row_mask:0xf bank_mask:0xf
  v_and_b32_dpp v29, v14, v5 row_newbcast:6 row_mask:0xf bank_mask:0xf
  v_and_b32_dpp v30, v14, v6 row_newbcast:6 row_mask:0xf bank_mask:0xf
  v_and_b32_dpp v31, v14, v7 row_newbcast:6 row_mask:0xf bank_mask:0xf
  v_mfma_f32_16x16x32_bf16 v[36:39], v[160:163], v[32:35], v[36:39]
  s_cbranch_scc1 L_a_198
  s_waitcnt vmcnt(3)
L_a_198:
  s_cbranch_vccnz L_b_199
  s_waitcnt vmcnt(4)
L_b_199:
  s_waitcnt vmcnt(6)
  buffer_load_dwordx4 v[200:203], v1, s[48:51], s14 offen nt
  v_add_u32 v1, s61, v1
  v_and_b32_dpp v32, v14, v4 row_newbcast:14 row_mask:0xf bank_mask:0xf
  v_and_b32_dpp v33, v14, v5 row_newbcast:14 row_mask:0xf bank_mask:0xf
  v_and_b32_dpp v34, v14, v6 row_newbcast:14 row_mask:0xf bank_mask:0xf
  v_and_b32_dpp v35, v14, v7 row_newbcast:14 row_mask:0xf bank_mask:0xf
  v_mfma_f32_16x16x32_bf16 v[36:39], v[164:167], v[28:31], v[36:39]
  s_cbranch_scc1 L_a_200
  s_waitcnt vmcnt(3)
L_a_200:
  s_cbranch_vccnz L_b_201
  s_waitcnt vmcnt(4)
L_b_201:
  s_waitcnt vmcnt(6)
  buffer_load_dwordx4 v[204:207], v1, s[48:51], s14 offen nt
  v_add_u32 v1, s61, v1
  v_and_b32_dpp v28, v14, v4 row_newbcast:3 row_mask:0xf bank_mask:0xf
  v_and_b32_dpp v29, v14, v5 row_newbcast:3 row_mask:0xf bank_mask:0xf
  v_and_b32_dpp v30, v14, v6 row_newbcast:3 row_mask:0xf bank_mask:0xf
  v_and_b32_dpp v31, v14, v7 row_newbcast:3 row_mask:0xf bank_mask:0xf
  v_mfma_f32_16x16x32_bf16 v[36:39], v[168:171], v[32:35], v[36:39]
  s_cmp_ge_i32 s60, 12
  s_cselect_b64 vcc, -1, 0
  s_cmp_ge_i32 s60, -12
  s_cbranch_scc1 L_a_202
  s_waitcnt vmcnt(3)
L_a_202:
  s_cbranch_vccnz L_b_203
  s_waitcnt vmcnt(4)
L_b_203:
  s_waitcnt vmcnt(6)
  buffer_load_dwordx4 v[208:211], v1, s[48:51], s14 offen nt
  v_add_u32 v1, s61, v1
  v_and_b32_dpp v32, v14, v4 row_newbcast:11 row_mask:0xf bank_mask:0xf
  v_and_b32_dpp v33, v14, v5 row_newbcast:11 row_mask:0xf bank_mask:0xf
  v_and_b32_dpp v34, v14, v6 row_newbcast:11 row_mask:0xf bank_mask:0xf
  v_and_b32_dpp v35, v14, v7 row_newbcast:11 row_mask:0xf bank_mask:0xf
  v_mfma_f32_16x16x32_bf16 v[36:39], v[176:179], v[28:31], v[36:39]
  s_cbranch_scc1 L_a_204
  s_waitcnt vmcnt(3)
L_a_204:
  s_cbranch_vccnz L_b_205
  s_waitcnt vmcnt(4)
L_b_205:
  s_waitcnt vmcnt(6)
  buffer_load_dwordx4 v[216:219], v1, s[48:51], s14 offen nt
  v_add_u32 v1, s61, v1
  v_and_b32_dpp v28, v14, v4 row_newbcast:7 row_mask:0xf bank_mask:0xf
  v_and_b32_dpp v29, v14, v5 row_newbcast:7 row_mask:0xf bank_mask:0xf
  v_and_b32_dpp v30, v14, v6 row_newbcast:7 row_mask:0xf bank_mask:0xf
  v_and_b32_dpp v31, v14, v7 row_newbcast:7 row_mask:0xf bank_mask:0xf
  v_mfma_f32_16x16x32_bf16 v[36:39], v[180:183], v[32:35], v[36:39]
  s_cbranch_scc1 L_a_206
  s_waitcnt vmcnt(3)
L_a_206:
  s_cbranch_vccnz L_b_207
  s_waitcnt vmcnt(4)
L_b_207:
  s_waitcnt vmcnt(6)
  buffer_load_dwordx4 v[220:223], v1, s[48:51], s14 offen nt
  v_add_u32 v1, s61, v1
  v_and_b32_dpp v32, v14, v4 row_newbcast:15 row_mask:0xf bank_mask:0xf
  v_and_b32_dpp v33, v14, v5 row_newbcast:15 row_mask:0xf bank_mask:0xf
  v_and_b32_dpp v34, v14, v6 row_newbcast:15 row_mask:0xf bank_mask:0xf
  v_and_b32_dpp v35, v14, v7 row_newbcast:15 row_mask:0xf bank_mask:0xf
  v_mfma_f32_16x16x32_bf16 v[36:39], v[184:187], v[28:31], v[36:39]
  s_cmp_ge_i32 s60, 15
  s_cselect_b64 vcc, -1, 0
  s_cmp_ge_i32 s60, -15
  s_cbranch_scc1 L_a_208
  s_waitcnt vmcnt(3)
L_a_208:
  s_cbranch_vccnz L_b_209
  s_waitcnt vmcnt(4)
L_b_209:
  s_waitcnt vmcnt(6)
  buffer_load_dwordx4 v[224:227], v1, s[48:51], s14 offen nt
  v_add_u32 v1, s61, v1
  v_and_b32_dpp v28, v15, v4 row_newbcast:0 row_mask:0xf bank_mask:0xf
  v_and_b32_dpp v29, v15, v5 row_newbcast:0 row_mask:0xf bank_mask:0xf
  v_and_b32_dpp v30, v15, v6 row_newbcast:0 row_mask:0xf bank_mask:0xf
  v_and_b32_dpp v31, v15, v7 row_newbcast:0 row_mask:0xf bank_mask:0xf
  v_mfma_f32_16x16x32_bf16 v[36:39], v[188:191], v[32:35], v[36:39]
  s_cbranch_scc1 L_a_210
  s_waitcnt vmcnt(3)
L_a_210:
  s_cbranch_vccnz L_b_211
  s_waitcnt vmcnt(4)
L_b_211:
  s_waitcnt vmcnt(6)
  buffer_load_dwordx4 v[228:231], v1, s[48:51], s14 offen nt
  v_add_u32 v1, s61, v1
  v_and_b32_dpp v32, v15, v4 row_newbcast:8 row_mask:0xf bank_mask:0xf
  v_and_b32_dpp v33, v15, v5 row_newbcast:8 row_mask:0xf bank_mask:0xf
  v_and_b32_dpp v34, v15, v6 row_newbcast:8 row_mask:0xf bank_mask:0xf
  v_and_b32_dpp v35, v15, v7 row_newbcast:8 row_mask:0xf bank_mask:0xf
  v_mfma_f32_16x16x32_bf16 v[36:39], v[196:199], v[28:31], v[36:39]
  s_cbranch_scc1 L_a_212
  s_waitcnt vmcnt(3)
L_a_212:
  s_cbranch_vccnz L_b_213
  s_waitcnt vmcnt(4)
L_b_213:
  s_waitcnt vmcnt(6)
  buffer_load_dwordx4 v[236:239], v1, s[48:51], s14 offen nt
  v_add_u32 v1, s61, v1
  v_and_b32_dpp v28, v15, v4 row_newbcast:4 row_mask:0xf bank_mask:0xf
  v_and_b32_dpp v29, v15, v5 row_newbcast:4 row_mask:0xf bank_mask:0xf
  v_and_b32_dpp v30, v15, v6 row_newbcast:4 row_mask:0xf bank_mask:0xf
  v_and_b32_dpp v31, v15, v7 row_newbcast:4 row_mask:0xf bank_mask:0xf
  v_mfma_f32_16x16x32_bf16 v[36:39], v[200:203], v[32:35], v[36:39]
  s_cmp_ge_i32 s60, 17
  s_cselect_b64 vcc, -1, 0
  s_cmp_ge_i32 s60, -17
  s_cbranch_scc1 L_a_214
  s_waitcnt vmcnt(3)
L_a_214:
  s_cbranch_vccnz L_b_215
  s_waitcnt vmcnt(4)
L_b_215:
  s_waitcnt vmcnt(6)
  buffer_load_dwordx4 v[240:243], v1, s[48:51], s14 offen nt
  v_add_u32 v1, s61, v1
  v_and_b32_dpp v32, v15, v4 row_newbcast:12 row_mask:0xf bank_mask:0xf
  v_and_b32_dpp v33, v15, v5 row_newbcast:12 row_mask:0xf bank_mask:0xf
  v_and_b32_dpp v34, v15, v6 row_newbcast:12 row_mask:0xf bank_mask:0xf
  v_and_b32_dpp v35, v15, v7 row_newbcast:12 row_mask:0xf bank_mask:0xf
  v_mfma_f32_16x16x32_bf16 v[36:39], v[204:207], v[28:31], v[36:39]
  s_cbranch_scc1 L_a_216
  s_waitcnt vmcnt(3)
L_a_216:
  s_cbranch_vccnz L_b_217
  s_waitcnt vmcnt(4)
L_b_217:
  s_waitcnt vmcnt(6)
  buffer_load_dwordx4 v[244:247], v1, s[48:51], s14 offen nt
  v_add_u32 v1, s61, v1
  v_and_b32_dpp v28, v15, v4 row_newbcast:1 row_mask:0xf bank_mask:0xf
  v_and_b32_dpp v29, v15, v5 row_newbcast:1 row_mask:0xf bank_mask:0xf
  v_and_b32_dpp v30, v15, v6 row_newbcast:1 row_mask:0xf bank_mask:0xf
  v_and_b32_dpp v31, v15, v7 row_newbcast:1 row_mask:0xf bank_mask:0xf
  v_mfma_f32_16x16x32_bf16 v[36:39], v[208:211], v[32:35], v[36:39]
  s_cbranch_scc1 L_a_218
  s_waitcnt vmcnt(3)
L_a_218:
  s_cbranch_vccnz L_b_219
  s_waitcnt vmcnt(4)
L_b_219:
  s_waitcnt vmcnt(6)
  buffer_load_dwordx4 v[248:251], v1, s[48:51], s14 offen nt
  v_add_u32 v1, s61, v1
  v_and_b32_dpp v32, v15, v4 row_newbcast:9 row_mask:0xf bank_mask:0xf
  v_and_b32_dpp v33, v15, v5 row_newbcast:9 row_mask:0xf bank_mask:0xf
  v_and_b32_dpp v34, v15, v6 row_newbcast:9 row_mask:0xf bank_mask:0xf
  v_and_b32_dpp v35, v15, v7 row_newbcast:9 row_mask:0xf bank_mask:0xf
  v_mfma_f32_16x16x32_bf16 v[36:39], v[216:219], v[28:31], v[36:39]
  s_cmp_ge_i32 s60, 20
  s_cselect_b64 vcc, -1, 0
  s_cmp_ge_i32 s60, -20
  s_cbranch_scc1 L_a_220
  s_waitcnt vmcnt(3)
L_a_220:
  s_cbranch_vccnz L_b_221
  s_waitcnt vmcnt(4)
L_b_221:
  s_waitcnt vmcnt(6)
  buffer_load_dwordx4 v[48:51], v1, s[48:51], s14 offen nt
  v_add_u32 v1, s61, v1
  v_and_b32_dpp v28, v15, v4 row_newbcast:5 row_mask:0xf bank_mask:0xf
  v_and_b32_dpp v29, v15, v5 row_newbcast:5 row_mask:0xf bank_mask:0xf
  v_and_b32_dpp v30, v15, v6 row_newbcast:5 row_mask:0xf bank_mask:0xf
  v_and_b32_dpp v31, v15, v7 row_newbcast:5 row_mask:0xf bank_mask:0xf
  v_mfma_f32_16x16x32_bf16 v[36:39], v[220:223], v[32:35], v[36:39]
  s_cbranch_scc1 L_a_222
  s_waitcnt vmcnt(3)
L_a_222:
  s_cbranch_vccnz L_b_223
  s_waitcnt vmcnt(4)
L_b_223:
  s_waitcnt vmcnt(6)
  buffer_load_dwordx4 v[52:55], v1, s[48:51], s14 offen nt
  v_add_u32 v1, s61, v1
  v_mov_b32 v47, 1
  s_mov_b64 exec, 1
  buffer_atomic_add v47, v45, s[52:55], s56 offen offset:768 sc0
  s_mov_b64 exec, -1
  v_and_b32_dpp v32, v15, v4 row_newbcast:13 row_mask:0xf bank_mask:0xf
  v_and_b32_dpp v33, v15, v5 row_newbcast:13 row_mask:0xf bank_mask:0xf
  v_and_b32_dpp v34, v15, v6 row_newbcast:13 row_mask:0xf bank_mask:0xf
  v_and_b32_dpp v35, v15, v7 row_newbcast:13 row_mask:0xf bank_mask:0xf
  v_mfma_f32_16x16x32_bf16 v[36:39], v[224:227], v[28:31], v[36:39]
  s_cbranch_scc1 L_a_224
  s_waitcnt vmcnt(4)
L_a_224:
  s_cbranch_vccnz L_b_225
  s_waitcnt vmcnt(5)
L_b_225:
  s_waitcnt vmcnt(7)
  buffer_load_dwordx4 v[56:59], v1, s[48:51], s14 offen nt
  v_add_u32 v1, s61, v1
  v_and_b32_dpp v28, v15, v4 row_newbcast:2 row_mask:0xf bank_mask:0xf
  v_and_b32_dpp v29, v15, v5 row_newbcast:2 row_mask:0xf bank_mask:0xf
  v_and_b32_dpp v30, v15, v6 row_newbcast:2 row_mask:0xf bank_mask:0xf
  v_and_b32_dpp v31, v15, v7 row_newbcast:2 row_mask:0xf bank_mask:0xf
  v_mfma_f32_16x16x32_bf16 v[36:39], v[228:231], v[32:35], v[36:39]
  s_cmp_ge_i32 s60, 22
  s_cselect_b64 vcc, -1, 0
  s_cmp_ge_i32 s60, -22
  s_cbranch_scc1 L_a_226
  s_waitcnt vmcnt(4)
L_a_226:
  s_cbranch_vccnz L_b_227
  s_waitcnt vmcnt(5)
L_b_227:
  s_waitcnt vmcnt(7)
  buffer_load_dwordx4 v[60:63], v1, s[48:51], s14 offen nt
  v_add_u32 v1, s61, v1
  v_and_b32_dpp v32, v15, v4 row_newbcast:10 row_mask:0xf bank_mask:0xf
  v_and_b32_dpp v33, v15, v5 row_newbcast:10 row_mask:0xf bank_mask:0xf
  v_and_b32_dpp v34, v15, v6 row_newbcast:10 row_mask:0xf bank_mask:0xf
  v_and_b32_dpp v35, v15, v7 row_newbcast:10 row_mask:0xf bank_mask:0xf
  v_mfma_f32_16x16x32_bf16 v[36:39], v[236:239], v[28:31], v[36:39]
  s_cbranch_scc1 L_a_228
  s_waitcnt vmcnt(4)
L_a_228:
  s_cbranch_vccnz L_b_229
  s_waitcnt vmcnt(5)
L_b_229:
  s_waitcnt vmcnt(7)
  buffer_load_dwordx4 v[64:67], v1, s[48:51], s14 offen nt
  v_add_u32 v1, s61, v1
  v_and_b32_dpp v28, v15, v4 row_newbcast:6 row_mask:0xf bank_mask:0xf
  v_and_b32_dpp v29, v15, v5 row_newbcast:6 row_mask:0xf bank_mask:0xf
  v_and_b32_dpp v30, v15, v6 row_newbcast:6 row_mask:0xf bank_mask:0xf
  v_and_b32_dpp v31, v15, v7 row_newbcast:6 row_mask:0xf bank_mask:0xf
  v_mfma_f32_16x16x32_bf16 v[36:39], v[240:243], v[32:35], v[36:39]
  s_cbranch_scc1 L_a_230
  s_waitcnt vmcnt(4)
L_a_230:
  s_cbranch_vccnz L_b_231
  s_waitcnt vmcnt(5)
L_b_231:
  s_waitcnt vmcnt(7)
  buffer_load_dwordx4 v[68:71], v1, s[48:51], s14 offen nt
  v_add_u32 v1, s61, v1
  v_and_b32_dpp v32, v15, v4 row_newbcast:14 row_mask:0xf bank_mask:0xf
  v_and_b32_dpp v33, v15, v5 row_newbcast:14 row_mask:0xf bank_mask:0xf
  v_and_b32_dpp v34, v15, v6 row_newbcast:14 row_mask:0xf bank_mask:0xf
  v_and_b32_dpp v35, v15, v7 row_newbcast:14 row_mask:0xf bank_mask:0xf
  v_mfma_f32_16x16x32_bf16 v[36:39], v[244:247], v[28:31], v[36:39]
  s_cmp_ge_i32 s60, 24
  s_cselect_b64 vcc, -1, 0
  s_cmp_ge_i32 s60, -24
  s_cbranch_scc1 L_a_232
  s_waitcnt vmcnt(3)
L_a_232:
  s_cbranch_vccnz L_b_233
  s_waitcnt vmcnt(5)
L_b_233:
  s_waitcnt vmcnt(7)
  buffer_load_dwordx4 v[72:75], v1, s[48:51], s14 offen nt
  v_add_u32 v1, s61, v1
  v_and_b32_dpp v28, v15, v4 row_newbcast:3 row_mask:0xf bank_mask:0xf
  v_and_b32_dpp v29, v15, v5 row_newbcast:3 row_mask:0xf bank_mask:0xf
  v_and_b32_dpp v30, v15, v6 row_newbcast:3 row_mask:0xf bank_mask:0xf
  v_and_b32_dpp v31, v15, v7 row_newbcast:3 row_mask:0xf bank_mask:0xf
  v_mfma_f32_16x16x32_bf16 v[36:39], v[248:251], v[32:35], v[36:39]
  s_cbranch_scc1 L_a_234
  s_waitcnt vmcnt(3)
L_a_234:
  s_cbranch_vccnz L_b_235
  s_waitcnt vmcnt(4)
L_b_235:
  s_waitcnt vmcnt(7)
  buffer_load_dwordx4 v[76:79], v1, s[48:51], s14 offen nt
  v_add_u32 v1, s61, v1
  v_and_b32_dpp v32, v15, v4 row_newbcast:11 row_mask:0xf bank_mask:0xf
  v_and_b32_dpp v33, v15, v5 row_newbcast:11 row_mask:0xf bank_mask:0xf
  v_and_b32_dpp v34, v15, v6 row_newbcast:11 row_mask:0xf bank_mask:0xf
  v_and_b32_dpp v35, v15, v7 row_newbcast:11 row_mask:0xf bank_mask:0xf
  v_mfma_f32_16x16x32_bf16 v[36:39], v[48:51], v[28:31], v[36:39]
  s_cbranch_scc1 L_a_236
  s_waitcnt vmcnt(3)
L_a_236:
  s_cbranch_vccnz L_b_237
  s_waitcnt vmcnt(4)
L_b_237:
  s_waitcnt vmcnt(7)
  buffer_load_dwordx4 v[80:83], v1, s[48:51], s14 offen nt
  v_add_u32 v1, s61, v1
  v_and_b32_dpp v28, v15, v4 row_newbcast:7 row_mask:0xf bank_mask:0xf
  v_and_b32_dpp v29, v15, v5 row_newbcast:7 row_mask:0xf bank_mask:0xf
  v_and_b32_dpp v30, v15, v6 row_newbcast:7 row_mask:0xf bank_mask:0xf
  v_and_b32_dpp v31, v15, v7 row_newbcast:7 row_mask:0xf bank_mask:0xf
  v_mfma_f32_16x16x32_bf16 v[36:39], v[52:55], v[32:35], v[36:39]
  s_cmp_ge_i32 s60, 27
  s_cselect_b64 vcc, -1, 0
  s_cmp_ge_i32 s60, -27
  s_cbranch_scc1 L_a_238
  s_waitcnt vmcnt(3)
L_a_238:
  s_cbranch_vccnz L_b_239
  s_waitcnt vmcnt(4)
L_b_239:
  s_waitcnt vmcnt(6)
  buffer_load_dwordx4 v[84:87], v1, s[48:51], s14 offen nt
  v_add_u32 v1, s61, v1
  v_subrev_u32 v47, 32, v47
  s_mov_b64 exec, 1
  ds_write_b32 v44, v47 offset:20
  s_mov_b64 exec, -1
  v_and_b32_dpp v32, v15, v4 row_newbcast:15 row_mask:0xf bank_mask:0xf
  v_and_b32_dpp v33, v15, v5 row_newbcast:15 row_mask:0xf bank_mask:0xf
  v_and_b32_dpp v34, v15, v6 row_newbcast:15 row_mask:0xf bank_mask:0xf
  v_and_b32_dpp v35, v15, v7 row_newbcast:15 row_mask:0xf bank_mask:0xf
  v_mfma_f32_16x16x32_bf16 v[36:39], v[56:59], v[28:31], v[36:39]
  s_cbranch_scc1 L_a_240
  s_waitcnt vmcnt(3)
L_a_240:
  s_cbranch_vccnz L_b_241
  s_waitcnt vmcnt(4)
L_b_241:
  s_waitcnt vmcnt(6)
  buffer_load_dwordx4 v[88:91], v1, s[48:51], s14 offen nt
  v_add_u32 v1, s61, v1
  ds_read_b32 v46, v2 offset:20
  v_and_b32_dpp v28, v16, v4 row_newbcast:0 row_mask:0xf bank_mask:0xf
  v_and_b32_dpp v29, v16, v5 row_newbcast:0 row_mask:0xf bank_mask:0xf
  v_and_b32_dpp v30, v16, v6 row_newbcast:0 row_mask:0xf bank_mask:0xf
  v_and_b32_dpp v31, v16, v7 row_newbcast:0 row_mask:0xf bank_mask:0xf
  v_mfma_f32_16x16x32_bf16 v[36:39], v[60:63], v[32:35], v[36:39]
  s_waitcnt lgkmcnt(0)
  v_readfirstlane_b32 s60, v46
  s_cmp_ge_i32 s60, 5
  s_cselect_b64 vcc, -1, 0
  s_cmp_ge_i32 s60, -5
  s_cbranch_scc1 L_a_242
  s_waitcnt vmcnt(3)
L_a_242:
  s_cbranch_vccnz L_b_243
  s_waitcnt vmcnt(4)
L_b_243:
  s_waitcnt vmcnt(6)
  buffer_load_dwordx4 v[92:95], v1, s[48:51], s14 offen nt
  v_add_u32 v1, s61, v1
  v_and_b32_dpp v32, v16, v4 row_newbcast:8 row_mask:0xf bank_mask:0xf
  v_and_b32_dpp v33, v16, v5 row_newbcast:8 row_mask:0xf bank_mask:0xf
  v_and_b32_dpp v34, v16, v6 row_newbcast:8 row_mask:0xf bank_mask:0xf
  v_and_b32_dpp v35, v16, v7 row_newbcast:8 row_mask:0xf bank_mask:0xf
  v_mfma_f32_16x16x32_bf16 v[36:39], v[64:67], v[28:31], v[36:39]
  s_cbranch_scc1 L_a_244
  s_waitcnt vmcnt(3)
L_a_244:
  s_cbranch_vccnz L_b_245
  s_waitcnt vmcnt(4)
L_b_245:
  s_waitcnt vmcnt(6)
  buffer_load_dwordx4 v[96:99], v1, s[48:51], s14 offen nt
  v_add_u32 v1, s61, v1
  v_and_b32_dpp v28, v16, v4 row_newbcast:4 row_mask:0xf bank_mask:0xf
  v_and_b32_dpp v29, v16, v5 row_newbcast:4 row_mask:0xf bank_mask:0xf
  v_and_b32_dpp v30, v16, v6 row_newbcast:4 row_mask:0xf bank_mask:0xf
  v_and_b32_dpp v31, v16, v7 row_newbcast:4 row_mask:0xf bank_mask:0xf
  v_mfma_f32_16x16x32_bf16 v[36:39], v[68:71], v[32:35], v[36:39]
  s_cbranch_scc1 L_a_246
  s_waitcnt vmcnt(3)
L_a_246:
  s_cbranch_vccnz L_b_247
  s_waitcnt vmcnt(4)
L_b_247:
  s_waitcnt vmcnt(6)
  buffer_load_dwordx4 v[132:135], v1, s[48:51], s14 offen nt
  v_add_u32 v1, s61, v1
  ds_read_b32 v46, v2 offset:20
  v_and_b32_dpp v32, v16, v4 row_newbcast:12 row_mask:0xf bank_mask:0xf
  v_and_b32_dpp v33, v16, v5 row_newbcast:12 row_mask:0xf bank_mask:0xf
  v_and_b32_dpp v34, v16, v6 row_newbcast:12 row_mask:0xf bank_mask:0xf
  v_and_b32_dpp v35, v16, v7 row_newbcast:12 row_mask:0xf bank_mask:0xf
  v_mfma_f32_16x16x32_bf16 v[36:39], v[72:75], v[28:31], v[36:39]
  s_waitcnt lgkmcnt(0)
  v_readfirstlane_b32 s60, v46
  s_cmp_ge_i32 s60, 5
  s_cselect_b64 vcc, -1, 0
  s_cmp_ge_i32 s60, -5
  s_cbranch_scc1 L_a_248
  s_waitcnt vmcnt(3)
L_a_248:
  s_cbranch_vccnz L_b_249
  s_waitcnt vmcnt(4)
L_b_249:
  s_waitcnt vmcnt(6)
  buffer_load_dwordx4 v[152:155], v1, s[48:51], s14 offen nt
  v_add_u32 v1, s61, v1
  v_and_b32_dpp v28, v16, v4 row_newbcast:1 row_mask:0xf bank_mask:0xf
  v_and_b32_dpp v29, v16, v5 row_newbcast:1 row_mask:0xf bank_mask:0xf
  v_and_b32_dpp v30, v16, v6 row_newbcast:1 row_mask:0xf bank_mask:0xf
  v_and_b32_dpp v31, v16, v7 row_newbcast:1 row_mask:0xf bank_mask:0xf
  v_mfma_f32_16x16x32_bf16 v[36:39], v[76:79], v[32:35], v[36:39]
  s_cbranch_scc1 L_a_250
  s_waitcnt vmcnt(3)
L_a_250:
  s_cbranch_vccnz L_b_251
  s_waitcnt vmcnt(4)
L_b_251:
  s_waitcnt vmcnt(6)
  buffer_load_dwordx4 v[172:175], v1, s[48:51], s14 offen nt
  v_add_u32 v1, s61, v1
  v_and_b32_dpp v32, v16, v4 row_newbcast:9 row_mask:0xf bank_mask:0xf
  v_and_b32_dpp v33, v16, v5 row_newbcast:9 row_mask:0xf bank_mask:0xf
  v_and_b32_dpp v34, v16, v6 row_newbcast:9 row_mask:0xf bank_mask:0xf
  v_and_b32_dpp v35, v16, v7 row_newbcast:9 row_mask:0xf bank_mask:0xf
  v_mfma_f32_16x16x32_bf16 v[36:39], v[80:83], v[28:31], v[36:39]
  s_cbranch_scc1 L_a_252
  s_waitcnt vmcnt(3)
L_a_252:
  s_cbranch_vccnz L_b_253
  s_waitcnt vmcnt(4)
L_b_253:
  s_waitcnt vmcnt(6)
  buffer_load_dwordx4 v[192:195], v1, s[48:51], s14 offen nt
  v_add_u32 v1, s61, v1
  v_and_b32_dpp v28, v16, v4 row_newbcast:5 row_mask:0xf bank_mask:0xf
  v_and_b32_dpp v29, v16, v5 row_newbcast:5 row_mask:0xf bank_mask:0xf
  v_and_b32_dpp v30, v16, v6 row_newbcast:5 row_mask:0xf bank_mask:0xf
  v_and_b32_dpp v31, v16, v7 row_newbcast:5 row_mask:0xf bank_mask:0xf
  v_mfma_f32_16x16x32_bf16 v[36:39], v[84:87], v[32:35], v[36:39]
  s_cmp_ge_i32 s60, 6
  s_cselect_b64 vcc, -1, 0
  s_cmp_ge_i32 s60, -6
  s_cbranch_scc1 L_a_254
  s_waitcnt vmcnt(3)
L_a_254:
  s_cbranch_vccnz L_b_255
  s_waitcnt vmcnt(4)
L_b_255:
  s_waitcnt vmcnt(6)
  buffer_load_dwordx4 v[212:215], v1, s[48:51], s14 offen nt
  v_add_u32 v1, s61, v1
  v_and_b32_dpp v32, v16, v4 row_newbcast:13 row_mask:0xf bank_mask:0xf
  v_and_b32_dpp v33, v16, v5 row_newbcast:13 row_mask:0xf bank_mask:0xf
  v_and_b32_dpp v34, v16, v6 row_newbcast:13 row_mask:0xf bank_mask:0xf
  v_and_b32_dpp v35, v16, v7 row_newbcast:13 row_mask:0xf bank_mask:0xf
  v_mfma_f32_16x16x32_bf16 v[36:39], v[88:91], v[28:31], v[36:39]
  s_cbranch_scc1 L_a_256
  s_waitcnt vmcnt(3)
L_a_256:
  s_cbranch_vccnz L_b_257
  s_waitcnt vmcnt(4)
L_b_257:
  s_waitcnt vmcnt(6)
  buffer_load_dwordx4 v[232:235], v1, s[48:51], s14 offen nt
  v_add_u32 v1, s61, v1
  v_and_b32_dpp v28, v16, v4 row_newbcast:2 row_mask:0xf bank_mask:0xf
  v_and_b32_dpp v29, v16, v5 row_newbcast:2 row_mask:0xf bank_mask:0xf
  v_and_b32_dpp v30, v16, v6 row_newbcast:2 row_mask:0xf bank_mask:0xf
  v_and_b32_dpp v31, v16, v7 row_newbcast:2 row_mask:0xf bank_mask:0xf
  v_mfma_f32_16x16x32_bf16 v[36:39], v[92:95], v[32:35], v[36:39]
  s_cbranch_scc1 L_a_258
  s_waitcnt vmcnt(3)
L_a_258:
  s_cbranch_vccnz L_b_259
  s_waitcnt vmcnt(4)
L_b_259:
  s_waitcnt vmcnt(6)
  buffer_load_dwordx4 v[252:255], v1, s[48:51], s14 offen nt
  v_add_u32 v1, s61, v1
  v_and_b32_dpp v32, v16, v4 row_newbcast:10 row_mask:0xf bank_mask:0xf
  v_and_b32_dpp v33, v16, v5 row_newbcast:10 row_mask:0xf bank_mask:0xf
  v_and_b32_dpp v34, v16, v6 row_newbcast:10 row_mask:0xf bank_mask:0xf
  v_and_b32_dpp v35, v16, v7 row_newbcast:10 row_mask:0xf bank_mask:0xf
  v_mfma_f32_16x16x32_bf16 v[36:39], v[96:99], v[28:31], v[36:39]
  s_cmp_ge_i32 s60, 9
  s_cselect_b64 vcc, -1, 0
  s_cmp_ge_i32 s60, -9
  s_cbranch_scc1 L_a_260
  s_waitcnt vmcnt(3)
L_a_260:
  s_cbranch_vccnz L_b_261
  s_waitcnt vmcnt(4)
L_b_261:
  s_waitcnt vmcnt(6)
  buffer_load_dwordx4 v[100:103], v1, s[48:51], s14 offen nt
  v_add_u32 v1, s61, v1
  v_and_b32_dpp v28, v16, v4 row_newbcast:6 row_mask:0xf bank_mask:0xf
  v_and_b32_dpp v29, v16, v5 row_newbcast:6 row_mask:0xf bank_mask:0xf
  v_and_b32_dpp v30, v16, v6 row_newbcast:6 row_mask:0xf bank_mask:0xf
  v_and_b32_dpp v31, v16, v7 row_newbcast:6 row_mask:0xf bank_mask:0xf
  v_mfma_f32_16x16x32_bf16 v[36:39], v[132:135], v[32:35], v[36:39]
  s_cbranch_scc1 L_a_262
  s_waitcnt vmcnt(3)
L_a_262:
  s_cbranch_vccnz L_b_263
  s_waitcnt vmcnt(4)
L_b_263:
  s_waitcnt vmcnt(6)
  buffer_load_dwordx4 v[104:107], v1, s[48:51], s14 offen nt
  v_add_u32 v1, s61, v1
  v_and_b32_dpp v32, v16, v4 row_newbcast:14 row_mask:0xf bank_mask:0xf
  v_and_b32_dpp v33, v16, v5 row_newbcast:14 row_mask:0xf bank_mask:0xf
  v_and_b32_dpp v34, v16, v6 row_newbcast:14 row_mask:0xf bank_mask:0xf
  v_and_b32_dpp v35, v16, v7 row_newbcast:14 row_mask:0xf bank_mask:0xf
  v_mfma_f32_16x16x32_bf16 v[36:39], v[152:155], v[28:31], v[36:39]
  s_cbranch_scc1 L_a_264
  s_waitcnt vmcnt(3)
L_a_264:
  s_cbranch_vccnz L_b_265
  s_waitcnt vmcnt(4)
L_b_265:
  s_waitcnt vmcnt(6)
  buffer_load_dwordx4 v[108:111], v1, s[48:51], s14 offen nt
  v_add_u32 v1, s61, v1
  v_and_b32_dpp v28, v16, v4 row_newbcast:3 row_mask:0xf bank_mask:0xf
  v_and_b32_dpp v29, v16, v5 row_newbcast:3 row_mask:0xf bank_mask:0xf
  v_and_b32_dpp v30, v16, v6 row_newbcast:3 row_mask:0xf bank_mask:0xf
  v_and_b32_dpp v31, v16, v7 row_newbcast:3 row_mask:0xf bank_mask:0xf
  v_mfma_f32_16x16x32_bf16 v[36:39], v[172:175], v[32:35], v[36:39]
  s_cmp_ge_i32 s60, 12
  s_cselect_b64 vcc, -1, 0
  s_cmp_ge_i32 s60, -12
  s_cbranch_scc1 L_a_266
  s_waitcnt vmcnt(3)
L_a_266:
  s_cbranch_vccnz L_b_267
  s_waitcnt vmcnt(4)
L_b_267:
  s_waitcnt vmcnt(6)
  buffer_load_dwordx4 v[112:115], v1, s[48:51], s14 offen nt
  v_add_u32 v1, s61, v1
  v_and_b32_dpp v32, v16, v4 row_newbcast:11 row_mask:0xf bank_mask:0xf
  v_and_b32_dpp v33, v16, v5 row_newbcast:11 row_mask:0xf bank_mask:0xf
  v_and_b32_dpp v34, v16, v6 row_newbcast:11 row_mask:0xf bank_mask:0xf
  v_and_b32_dpp v35, v16, v7 row_newbcast:11 row_mask:0xf bank_mask:0xf
  v_mfma_f32_16x16x32_bf16 v[36:39], v[192:195], v[28:31], v[36:39]
  s_cbranch_scc1 L_a_268
  s_waitcnt vmcnt(3)
L_a_268:
  s_cbranch_vccnz L_b_269
  s_waitcnt vmcnt(4)
L_b_269:
  s_waitcnt vmcnt(6)
  buffer_load_dwordx4 v[116:119], v1, s[48:51], s14 offen nt
  v_add_u32 v1, s61, v1
  v_and_b32_dpp v28, v16, v4 row_newbcast:7 row_mask:0xf bank_mask:0xf
  v_and_b32_dpp v29, v16, v5 row_newbcast:7 row_mask:0xf bank_mask:0xf
  v_and_b32_dpp v30, v16, v6 row_newbcast:7 row_mask:0xf bank_mask:0xf
  v_and_b32_dpp v31, v16, v7 row_newbcast:7 row_mask:0xf bank_mask:0xf
  v_mfma_f32_16x16x32_bf16 v[36:39], v[212:215], v[32:35], v[36:39]
  s_cbranch_scc1 L_a_270
  s_waitcnt vmcnt(3)
L_a_270:
  s_cbranch_vccnz L_b_271
  s_waitcnt vmcnt(4)
L_b_271:
  s_waitcnt vmcnt(6)
  buffer_load_dwordx4 v[120:123], v1, s[48:51], s14 offen nt
  v_add_u32 v1, s61, v1
  v_and_b32_dpp v32, v16, v4 row_newbcast:15 row_mask:0xf bank_mask:0xf
  v_and_b32_dpp v33, v16, v5 row_newbcast:15 row_mask:0xf bank_mask:0xf
  v_and_b32_dpp v34, v16, v6 row_newbcast:15 row_mask:0xf bank_mask:0xf
  v_and_b32_dpp v35, v16, v7 row_newbcast:15 row_mask:0xf bank_mask:0xf
  v_mfma_f32_16x16x32_bf16 v[36:39], v[232:235], v[28:31], v[36:39]
  s_cmp_ge_i32 s60, 15
  s_cselect_b64 vcc, -1, 0
  s_cmp_ge_i32 s60, -15
  s_cbranch_scc1 L_a_272
  s_waitcnt vmcnt(3)
L_a_272:
  s_cbranch_vccnz L_b_273
  s_waitcnt vmcnt(4)
L_b_273:
  s_waitcnt vmcnt(6)
  buffer_load_dwordx4 v[124:127], v1, s[48:51], s14 offen nt
  v_add_u32 v1, s61, v1
  v_and_b32_dpp v28, v17, v4 row_newbcast:0 row_mask:0xf bank_mask:0xf
  v_and_b32_dpp v29, v17, v5 row_newbcast:0 row_mask:0xf bank_mask:0xf
  v_and_b32_dpp v30, v17, v6 row_newbcast:0 row_mask:0xf bank_mask:0xf
  v_and_b32_dpp v31, v17, v7 row_newbcast:0 row_mask:0xf bank_mask:0xf
  v_mfma_f32_16x16x32_bf16 v[36:39], v[252:255], v[32:35], v[36:39]
  s_cbranch_scc1 L_a_274
  s_waitcnt vmcnt(3)
L_a_274:
  s_cbranch_vccnz L_b_275
  s_waitcnt vmcnt(4)
L_b_275:
  s_waitcnt vmcnt(6)
  buffer_load_dwordx4 v[128:131], v1, s[48:51], s14 offen nt
  v_add_u32 v1, s61, v1
  v_and_b32_dpp v32, v17, v4 row_newbcast:8 row_mask:0xf bank_mask:0xf
  v_and_b32_dpp v33, v17, v5 row_newbcast:8 row_mask:0xf bank_mask:0xf
  v_and_b32_dpp v34, v17, v6 row_newbcast:8 row_mask:0xf bank_mask:0xf
  v_and_b32_dpp v35, v17, v7 row_newbcast:8 row_mask:0xf bank_mask:0xf
  v_mfma_f32_16x16x32_bf16 v[36:39], v[100:103], v[28:31], v[36:39]
  s_cbranch_scc1 L_a_276
  s_waitcnt vmcnt(3)
L_a_276:
  s_cbranch_vccnz L_b_277
  s_waitcnt vmcnt(4)
L_b_277:
  s_waitcnt vmcnt(6)
  buffer_load_dwordx4 v[136:139], v1, s[48:51], s14 offen nt
  v_add_u32 v1, s61, v1
  v_and_b32_dpp v28, v17, v4 row_newbcast:4 row_mask:0xf bank_mask:0xf
  v_and_b32_dpp v29, v17, v5 row_newbcast:4 row_mask:0xf bank_mask:0xf
  v_and_b32_dpp v30, v17, v6 row_newbcast:4 row_mask:0xf bank_mask:0xf
  v_and_b32_dpp v31, v17, v7 row_newbcast:4 row_mask:0xf bank_mask:0xf
  v_mfma_f32_16x16x32_bf16 v[36:39], v[104:107], v[32:35], v[36:39]
  s_cmp_ge_i32 s60, 18
  s_cselect_b64 vcc, -1, 0
  s_cmp_ge_i32 s60, -18
  s_cbranch_scc1 L_a_278
  s_waitcnt vmcnt(3)
L_a_278:
  s_cbranch_vccnz L_b_279
  s_waitcnt vmcnt(4)
L_b_279:
  s_waitcnt vmcnt(6)
  buffer_load_dwordx4 v[140:143], v1, s[48:51], s14 offen nt
  v_add_u32 v1, s61, v1
  v_and_b32_dpp v32, v17, v4 row_newbcast:12 row_mask:0xf bank_mask:0xf
  v_and_b32_dpp v33, v17, v5 row_newbcast:12 row_mask:0xf bank_mask:0xf
  v_and_b32_dpp v34, v17, v6 row_newbcast:12 row_mask:0xf bank_mask:0xf
  v_and_b32_dpp v35, v17, v7 row_newbcast:12 row_mask:0xf bank_mask:0xf
  v_mfma_f32_16x16x32_bf16 v[36:39], v[108:111], v[28:31], v[36:39]
  s_cbranch_scc1 L_a_280
  s_waitcnt vmcnt(3)
L_a_280:
  s_cbranch_vccnz L_b_281
  s_waitcnt vmcnt(4)
L_b_281:
  s_waitcnt vmcnt(6)
  buffer_load_dwordx4 v[144:147], v1, s[48:51], s14 offen nt
  v_add_u32 v1, s61, v1
  v_and_b32_dpp v28, v17, v4 row_newbcast:1 row_mask:0xf bank_mask:0xf
  v_and_b32_dpp v29, v17, v5 row_newbcast:1 row_mask:0xf bank_mask:0xf
  v_and_b32_dpp v30, v17, v6 row_newbcast:1 row_mask:0xf bank_mask:0xf
  v_and_b32_dpp v31, v17, v7 row_newbcast:1 row_mask:0xf bank_mask:0xf
  v_mfma_f32_16x16x32_bf16 v[36:39], v[112:115], v[32:35], v[36:39]
  s_cbranch_scc1 L_a_282
  s_waitcnt vmcnt(3)
L_a_282:
  s_cbranch_vccnz L_b_283
  s_waitcnt vmcnt(4)
L_b_283:
  s_waitcnt vmcnt(6)
  buffer_load_dwordx4 v[148:151], v1, s[48:51], s14 offen nt
  v_add_u32 v1, s61, v1
  v_and_b32_dpp v32, v17, v4 row_newbcast:9 row_mask:0xf bank_mask:0xf
  v_and_b32_dpp v33, v17, v5 row_newbcast:9 row_mask:0xf bank_mask:0xf
  v_and_b32_dpp v34, v17, v6 row_newbcast:9 row_mask:0xf bank_mask:0xf
  v_and_b32_dpp v35, v17, v7 row_newbcast:9 row_mask:0xf bank_mask:0xf
  v_mfma_f32_16x16x32_bf16 v[36:39], v[116:119], v[28:31], v[36:39]
  s_cmp_ge_i32 s60, 21
  s_cselect_b64 vcc, -1, 0
  s_cmp_ge_i32 s60, -21
  s_cbranch_scc1 L_a_284
  s_waitcnt vmcnt(3)
L_a_284:
  s_cbranch_vccnz L_b_285
  s_waitcnt vmcnt(4)
L_b_285:
  s_waitcnt vmcnt(6)
  buffer_load_dwordx4 v[156:159], v1, s[48:51], s14 offen nt
  v_add_u32 v1, s61, v1
  v_and_b32_dpp v28, v17, v4 row_newbcast:5 row_mask:0xf bank_mask:0xf
  v_and_b32_dpp v29, v17, v5 row_newbcast:5 row_mask:0xf bank_mask:0xf
  v_and_b32_dpp v30, v17, v6 row_newbcast:5 row_mask:0xf bank_mask:0xf
  v_and_b32_dpp v31, v17, v7 row_newbcast:5 row_mask:0xf bank_mask:0xf
  v_mfma_f32_16x16x32_bf16 v[36:39], v[120:123], v[32:35], v[36:39]
  s_cbranch_scc1 L_a_286
  s_waitcnt vmcnt(3)
L_a_286:
  s_cbranch_vccnz L_b_287
  s_waitcnt vmcnt(4)
L_b_287:
  s_waitcnt vmcnt(6)
  buffer_load_dwordx4 v[160:163], v1, s[48:51], s14 offen nt
  v_add_u32 v1, s61, v1
  v_mov_b32 v47, 1
  s_mov_b64 exec, 1
  buffer_atomic_add v47, v45, s[52:55], s68 offen offset:1024 sc0
  s_mov_b64 exec, -1
  v_and_b32_dpp v32, v17, v4 row_newbcast:13 row_mask:0xf bank_mask:0xf
  v_and_b32_dpp v33, v17, v5 row_newbcast:13 row_mask:0xf bank_mask:0xf
  v_and_b32_dpp v34, v17, v6 row_newbcast:13 row_mask:0xf bank_mask:0xf
  v_and_b32_dpp v35, v17, v7 row_newbcast:13 row_mask:0xf bank_mask:0xf
  v_mfma_f32_16x16x32_bf16 v[36:39], v[124:127], v[28:31], v[36:39]
  s_cbranch_scc1 L_a_288
  s_waitcnt vmcnt(4)
L_a_288:
  s_cbranch_vccnz L_b_289
  s_waitcnt vmcnt(5)
L_b_289:
  s_waitcnt vmcnt(7)
  buffer_load_dwordx4 v[164:167], v1, s[48:51], s14 offen nt
  v_add_u32 v1, s61, v1
  v_and_b32_dpp v28, v17, v4 row_newbcast:2 row_mask:0xf bank_mask:0xf
  v_and_b32_dpp v29, v17, v5 row_newbcast:2 row_mask:0xf bank_mask:0xf
  v_and_b32_dpp v30, v17, v6 row_newbcast:2 row_mask:0xf bank_mask:0xf
  v_and_b32_dpp v31, v17, v7 row_newbcast:2 row_mask:0xf bank_mask:0xf
  v_mfma_f32_16x16x32_bf16 v[36:39], v[128:131], v[32:35], v[36:39]
  s_cmp_ge_i32 s60, 24
  s_cselect_b64 vcc, -1, 0
  s_cmp_ge_i32 s60, -24
  s_cbranch_scc1 L_a_290
  s_waitcnt vmcnt(4)
L_a_290:
  s_cbranch_vccnz L_b_291
  s_waitcnt vmcnt(5)
L_b_291:
  s_waitcnt vmcnt(7)
  buffer_load_dwordx4 v[168:171], v1, s[48:51], s14 offen nt
  v_add_u32 v1, s61, v1
  v_and_b32_dpp v32, v17, v4 row_newbcast:10 row_mask:0xf bank_mask:0xf
  v_and_b32_dpp v33, v17, v5 row_newbcast:10 row_mask:0xf bank_mask:0xf
  v_and_b32_dpp v34, v17, v6 row_newbcast:10 row_mask:0xf bank_mask:0xf
  v_and_b32_dpp v35, v17, v7 row_newbcast:10 row_mask:0xf bank_mask:0xf
  v_mfma_f32_16x16x32_bf16 v[36:39], v[136:139], v[28:31], v[36:39]
  s_cbranch_scc1 L_a_292
  s_waitcnt vmcnt(4)
L_a_292:
  s_cbranch_vccnz L_b_293
  s_waitcnt vmcnt(5)
L_b_293:
  s_waitcnt vmcnt(7)
  buffer_load_dwordx4 v[176:179], v1, s[48:51], s14 offen nt
  v_add_u32 v1, s61, v1
  v_and_b32_dpp v28, v17, v4 row_newbcast:6 row_mask:0xf bank_mask:0xf
  v_and_b32_dpp v29, v17, v5 row_newbcast:6 row_mask:0xf bank_mask:0xf
  v_and_b32_dpp v30, v17, v6 row_newbcast:6 row_mask:0xf bank_mask:0xf
  v_and_b32_dpp v31, v17, v7 row_newbcast:6 row_mask:0xf bank_mask:0xf
  v_mfma_f32_16x16x32_bf16 v[36:39], v[140:143], v[32:35], v[36:39]
  s_cbranch_scc1 L_a_294
  s_waitcnt vmcnt(4)
L_a_294:
  s_cbranch_vccnz L_b_295
  s_waitcnt vmcnt(5)
L_b_295:
  s_waitcnt vmcnt(7)
  buffer_load_dwordx4 v[180:183], v1, s[48:51], s14 offen nt
  v_add_u32 v1, s61, v1
  v_and_b32_dpp v32, v17, v4 row_newbcast:14 row_mask:0xf bank_mask:0xf
  v_and_b32_dpp v33, v17, v5 row_newbcast:14 row_mask:0xf bank_mask:0xf
  v_and_b32_dpp v34, v17, v6 row_newbcast:14 row_mask:0xf bank_mask:0xf
  v_and_b32_dpp v35, v17, v7 row_newbcast:14 row_mask:0xf bank_mask:0xf
  v_mfma_f32_16x16x32_bf16 v[36:39], v[144:147], v[28:31], v[36:39]
  s_cmp_ge_i32 s60, 27
  s_cselect_b64 vcc, -1, 0
  s_cmp_ge_i32 s60, -27
  s_cbranch_scc1 L_a_296
  s_waitcnt vmcnt(3)
L_a_296:
  s_cbranch_vccnz L_b_297
  s_waitcnt vmcnt(5)
L_b_297:
  s_waitcnt vmcnt(7)
  buffer_load_dwordx4 v[184:187], v1, s[48:51], s14 offen nt
  v_add_u32 v1, s61, v1
  v_and_b32_dpp v28, v17, v4 row_newbcast:3 row_mask:0xf bank_mask:0xf
  v_and_b32_dpp v29, v17, v5 row_newbcast:3 row_mask:0xf bank_mask:0xf
  v_and_b32_dpp v30, v17, v6 row_newbcast:3 row_mask:0xf bank_mask:0xf
  v_and_b32_dpp v31, v17, v7 row_newbcast:3 row_mask:0xf bank_mask:0xf
  v_mfma_f32_16x16x32_bf16 v[36:39], v[148:151], v[32:35], v[36:39]
  s_cbranch_scc1 L_a_298
  s_waitcnt vmcnt(3)
L_a_298:
  s_cbranch_vccnz L_b_299
  s_waitcnt vmcnt(4)
L_b_299:
  s_waitcnt vmcnt(7)
  buffer_load_dwordx4 v[188:191], v1, s[48:51], s14 offen nt
  v_add_u32 v1, s61, v1
  v_and_b32_dpp v32, v17, v4 row_newbcast:11 row_mask:0xf bank_mask:0xf
  v_and_b32_dpp v33, v17, v5 row_newbcast:11 row_mask:0xf bank_mask:0xf
  v_and_b32_dpp v34, v17, v6 row_newbcast:11 row_mask:0xf bank_mask:0xf
  v_and_b32_dpp v35, v17, v7 row_newbcast:11 row_mask:0xf bank_mask:0xf
  v_mfma_f32_16x16x32_bf16 v[36:39], v[156:159], v[28:31], v[36:39]
  s_cbranch_scc1 L_a_300
  s_waitcnt vmcnt(3)
L_a_300:
  s_cbranch_vccnz L_b_301
  s_waitcnt vmcnt(4)
L_b_301:
  s_waitcnt vmcnt(7)
  buffer_load_dwordx4 v[196:199], v1, s[48:51], s14 offen nt
  v_add_u32 v1, s61, v1
  v_and_b32_dpp v28, v17, v4 row_newbcast:7 row_mask:0xf bank_mask:0xf
  v_and_b32_dpp v29, v17, v5 row_newbcast:7 row_mask:0xf bank_mask:0xf
  v_and_b32_dpp v30, v17, v6 row_newbcast:7 row_mask:0xf bank_mask:0xf
  v_and_b32_dpp v31, v17, v7 row_newbcast:7 row_mask:0xf bank_mask:0xf
  v_mfma_f32_16x16x32_bf16 v[36:39], v[160:163], v[32:35], v[36:39]
  s_cmp_ge_i32 s60, 30
  s_cselect_b64 vcc, -1, 0
  s_cmp_ge_i32 s60, -30
  s_cbranch_scc1 L_a_302
  s_waitcnt vmcnt(3)
L_a_302:
  s_cbranch_vccnz L_b_303
  s_waitcnt vmcnt(4)
L_b_303:
  s_waitcnt vmcnt(6)
  buffer_load_dwordx4 v[200:203], v1, s[48:51], s14 offen nt
  v_add_u32 v1, s61, v1
  v_subrev_u32 v47, 32, v47
  s_mov_b64 exec, 1
  ds_write_b32 v44, v47 offset:20
  s_mov_b64 exec, -1
  v_and_b32_dpp v32, v17, v4 row_newbcast:15 row_mask:0xf bank_mask:0xf
  v_and_b32_dpp v33, v17, v5 row_newbcast:15 row_mask:0xf bank_mask:0xf
  v_and_b32_dpp v34, v17, v6 row_newbcast:15 row_mask:0xf bank_mask:0xf
  v_and_b32_dpp v35, v17, v7 row_newbcast:15 row_mask:0xf bank_mask:0xf
  v_mfma_f32_16x16x32_bf16 v[36:39], v[164:167], v[28:31], v[36:39]
  s_cbranch_scc1 L_a_304
  s_waitcnt vmcnt(3)
L_a_304:
  s_cbranch_vccnz L_b_305
  s_waitcnt vmcnt(4)
L_b_305:
  s_waitcnt vmcnt(6)
  buffer_load_dwordx4 v[204:207], v1, s[48:51], s14 offen nt
  v_add_u32 v1, s61, v1
  ds_read_b32 v46, v2 offset:20
  v_and_b32_dpp v28, v18, v4 row_newbcast:0 row_mask:0xf bank_mask:0xf
  v_and_b32_dpp v29, v18, v5 row_newbcast:0 row_mask:0xf bank_mask:0xf
  v_and_b32_dpp v30, v18, v6 row_newbcast:0 row_mask:0xf bank_mask:0xf
  v_and_b32_dpp v31, v18, v7 row_newbcast:0 row_mask:0xf bank_mask:0xf
  v_mfma_f32_16x16x32_bf16 v[36:39], v[168:171], v[32:35], v[36:39]
  s_waitcnt lgkmcnt(0)
  v_readfirstlane_b32 s60, v46
  s_cmp_ge_i32 s60, 5
  s_cselect_b64 vcc, -1, 0
  s_cmp_ge_i32 s60, -5
  s_cbranch_scc1 L_a_306
  s_waitcnt vmcnt(3)
L_a_306:
  s_cbranch_vccnz L_b_307
  s_waitcnt vmcnt(4)
L_b_307:
  s_waitcnt vmcnt(6)
  buffer_load_dwordx4 v[208:211], v1, s[48:51], s14 offen nt
  v_add_u32 v1, s61, v1
  v_and_b32_dpp v32, v18, v4 row_newbcast:8 row_mask:0xf bank_mask:0xf
  v_and_b32_dpp v33, v18, v5 row_newbcast:8 row_mask:0xf bank_mask:0xf
  v_and_b32_dpp v34, v18, v6 row_newbcast:8 row_mask:0xf bank_mask:0xf
  v_and_b32_dpp v35, v18, v7 row_newbcast:8 row_mask:0xf bank_mask:0xf
  v_mfma_f32_16x16x32_bf16 v[36:39], v[176:179], v[28:31], v[36:39]
  s_cbranch_scc1 L_a_308
  s_waitcnt vmcnt(3)
L_a_308:
  s_cbranch_vccnz L_b_309
  s_waitcnt vmcnt(4)
L_b_309:
  s_waitcnt vmcnt(6)
  buffer_load_dwordx4 v[216:219], v1, s[48:51], s14 offen nt
  v_add_u32 v1, s61, v1
  v_and_b32_dpp v28, v18, v4 row_newbcast:4 row_mask:0xf bank_mask:0xf
  v_and_b32_dpp v29, v18, v5 row_newbcast:4 row_mask:0xf bank_mask:0xf
  v_and_b32_dpp v30, v18, v6 row_newbcast:4 row_mask:0xf bank_mask:0xf
  v_and_b32_dpp v31, v18, v7 row_newbcast:4 row_mask:0xf bank_mask:0xf
  v_mfma_f32_16x16x32_bf16 v[36:39], v[180:183], v[32:35], v[36:39]
  s_cbranch_scc1 L_a_310
  s_waitcnt vmcnt(3)
L_a_310:
  s_cbranch_vccnz L_b_311
  s_waitcnt vmcnt(4)
L_b_311:
  s_waitcnt vmcnt(6)
  buffer_load_dwordx4 v[220:223], v1, s[48:51], s14 offen nt
  v_add_u32 v1, s61, v1
  ds_read_b32 v46, v2 offset:20
  v_and_b32_dpp v32, v18, v4 row_newbcast:12 row_mask:0xf bank_mask:0xf
  v_and_b32_dpp v33, v18, v5 row_newbcast:12 row_mask:0xf bank_mask:0xf
  v_and_b32_dpp v34, v18, v6 row_newbcast:12 row_mask:0xf bank_mask:0xf
  v_and_b32_dpp v35, v18, v7 row_newbcast:12 row_mask:0xf bank_mask:0xf
  v_mfma_f32_16x16x32_bf16 v[36:39], v[184:187], v[28:31], v[36:39]
  s_waitcnt lgkmcnt(0)
  v_readfirstlane_b32 s60, v46
  s_cmp_ge_i32 s60, 5
  s_cselect_b64 vcc, -1, 0
  s_cmp_ge_i32 s60, -5
  s_cbranch_scc1 L_a_312
  s_waitcnt vmcnt(3)
L_a_312:
  s_cbranch_vccnz L_b_313
  s_waitcnt vmcnt(4)
L_b_313:
  s_waitcnt vmcnt(6)
  buffer_load_dwordx4 v[224:227], v1, s[48:51], s14 offen nt
  v_add_u32 v1, s61, v1
  v_and_b32_dpp v28, v18, v4 row_newbcast:1 row_mask:0xf bank_mask:0xf
  v_and_b32_dpp v29, v18, v5 row_newbcast:1 row_mask:0xf bank_mask:0xf
  v_and_b32_dpp v30, v18, v6 row_newbcast:1 row_mask:0xf bank_mask:0xf
  v_and_b32_dpp v31, v18, v7 row_newbcast:1 row_mask:0xf bank_mask:0xf
  v_mfma_f32_16x16x32_bf16 v[36:39], v[188:191], v[32:35], v[36:39]
  s_cbranch_scc1 L_a_314
  s_waitcnt vmcnt(3)
L_a_314:
  s_cbranch_vccnz L_b_315
  s_waitcnt vmcnt(4)
L_b_315:
  s_waitcnt vmcnt(6)
  buffer_load_dwordx4 v[228:231], v1, s[48:51], s14 offen nt
  v_add_u32 v1, s61, v1
  v_and_b32_dpp v32, v18, v4 row_newbcast:9 row_mask:0xf bank_mask:0xf
  v_and_b32_dpp v33, v18, v5 row_newbcast:9 row_mask:0xf bank_mask:0xf
  v_and_b32_dpp v34, v18, v6 row_newbcast:9 row_mask:0xf bank_mask:0xf
  v_and_b32_dpp v35, v18, v7 row_newbcast:9 row_mask:0xf bank_mask:0xf
  v_mfma_f32_16x16x32_bf16 v[36:39], v[196:199], v[28:31], v[36:39]
  s_cbranch_scc1 L_a_316
  s_waitcnt vmcnt(3)
L_a_316:
  s_cbranch_vccnz L_b_317
  s_waitcnt vmcnt(4)
L_b_317:
  s_waitcnt vmcnt(6)
  buffer_load_dwordx4 v[236:239], v1, s[48:51], s14 offen nt
  v_add_u32 v1, s61, v1
  v_and_b32_dpp v28, v18, v4 row_newbcast:5 row_mask:0xf bank_mask:0xf
  v_and_b32_dpp v29, v18, v5 row_newbcast:5 row_mask:0xf bank_mask:0xf
  v_and_b32_dpp v30, v18, v6 row_newbcast:5 row_mask:0xf bank_mask:0xf
  v_and_b32_dpp v31, v18, v7 row_newbcast:5 row_mask:0xf bank_mask:0xf
  v_mfma_f32_16x16x32_bf16 v[36:39], v[200:203], v[32:35], v[36:39]
  s_cmp_ge_i32 s60, 8
  s_cselect_b64 vcc, -1, 0
  s_cmp_ge_i32 s60, -8
  s_cbranch_scc1 L_a_318
  s_waitcnt vmcnt(3)
L_a_318:
  s_cbranch_vccnz L_b_319
  s_waitcnt vmcnt(4)
L_b_319:
  s_waitcnt vmcnt(6)
  buffer_load_dwordx4 v[240:243], v1, s[48:51], s14 offen nt
  v_add_u32 v1, s61, v1
  v_and_b32_dpp v32, v18, v4 row_newbcast:13 row_mask:0xf bank_mask:0xf
  v_and_b32_dpp v33, v18, v5 row_newbcast:13 row_mask:0xf bank_mask:0xf
  v_and_b32_dpp v34, v18, v6 row_newbcast:13 row_mask:0xf bank_mask:0xf
  v_and_b32_dpp v35, v18, v7 row_newbcast:13 row_mask:0xf bank_mask:0xf
  v_mfma_f32_16x16x32_bf16 v[36:39], v[204:207], v[28:31], v[36:39]
  s_cbranch_scc1 L_a_320
  s_waitcnt vmcnt(3)
L_a_320:
  s_cbranch_vccnz L_b_321
  s_waitcnt vmcnt(4)
L_b_321:
  s_waitcnt vmcnt(6)
  buffer_load_dwordx4 v[244:247], v1, s[48:51], s14 offen nt
  v_add_u32 v1, s61, v1
  v_and_b32_dpp v28, v18, v4 row_newbcast:2 row_mask:0xf bank_mask:0xf
  v_and_b32_dpp v29, v18, v5 row_newbcast:2 row_mask:0xf bank_mask:0xf
  v_and_b32_dpp v30, v18, v6 row_newbcast:2 row_mask:0xf bank_mask:0xf
  v_and_b32_dpp v31, v18, v7 row_newbcast:2 row_mask:0xf bank_mask:0xf
  v_mfma_f32_16x16x32_bf16 v[36:39], v[208:211], v[32:35], v[36:39]
  s_cbranch_scc1 L_a_322
  s_waitcnt vmcnt(3)
L_a_322:
  s_cbranch_vccnz L_b_323
  s_waitcnt vmcnt(4)
L_b_323:
  s_waitcnt vmcnt(6)
  buffer_load_dwordx4 v[248:251], v1, s[48:51], s14 offen nt
  v_add_u32 v1, s61, v1
  v_and_b32_dpp v32, v18, v4 row_newbcast:10 row_mask:0xf bank_mask:0xf
  v_and_b32_dpp v33, v18, v5 row_newbcast:10 row_mask:0xf bank_mask:0xf
  v_and_b32_dpp v34, v18, v6 row_newbcast:10 row_mask:0xf bank_mask:0xf
  v_and_b32_dpp v35, v18, v7 row_newbcast:10 row_mask:0xf bank_mask:0xf
  v_mfma_f32_16x16x32_bf16 v[36:39], v[216:219], v[28:31], v[36:39]
  s_cmp_ge_i32 s60, 12
  s_cselect_b64 vcc, -1, 0
  s_cmp_ge_i32 s60, -12
  s_cbranch_scc1 L_a_324
  s_waitcnt vmcnt(3)
L_a_324:
  s_cbranch_vccnz L_b_325
  s_waitcnt vmcnt(4)
L_b_325:
  s_waitcnt vmcnt(6)
  buffer_load_dwordx4 v[48:51], v1, s[48:51], s14 offen nt
  v_add_u32 v1, s61, v1
  v_and_b32_dpp v28, v18, v4 row_newbcast:6 row_mask:0xf bank_mask:0xf
  v_and_b32_dpp v29, v18, v5 row_newbcast:6 row_mask:0xf bank_mask:0xf
  v_and_b32_dpp v30, v18, v6 row_newbcast:6 row_mask:0xf bank_mask:0xf
  v_and_b32_dpp v31, v18, v7 row_newbcast:6 row_mask:0xf bank_mask:0xf
  v_mfma_f32_16x16x32_bf16 v[36:39], v[220:223], v[32:35], v[36:39]
  s_cbranch_scc1 L_a_326
  s_waitcnt vmcnt(3)
L_a_326:
  s_cbranch_vccnz L_b_327
  s_waitcnt vmcnt(4)
L_b_327:
  s_waitcnt vmcnt(6)
  buffer_load_dwordx4 v[52:55], v1, s[48:51], s14 offen nt
  v_add_u32 v1, s61, v1
  v_and_b32_dpp v32, v18, v4 row_newbcast:14 row_mask:0xf bank_mask:0xf
  v_and_b32_dpp v33, v18, v5 row_newbcast:14 row_mask:0xf bank_mask:0xf
  v_and_b32_dpp v34, v18, v6 row_newbcast:14 row_mask:0xf bank_mask:0xf
  v_and_b32_dpp v35, v18, v7 row_newbcast:14 row_mask:0xf bank_mask:0xf
  v_mfma_f32_16x16x32_bf16 v[36:39], v[224:227], v[28:31], v[36:39]
  s_cbranch_scc1 L_a_328
  s_waitcnt vmcnt(3)
L_a_328:
  s_cbranch_vccnz L_b_329
  s_waitcnt vmcnt(4)
L_b_329:
  s_waitcnt vmcnt(6)
  buffer_load_dwordx4 v[56:59], v1, s[48:51], s14 offen nt
  v_add_u32 v1, s61, v1
  v_and_b32_dpp v28, v18, v4 row_newbcast:3 row_mask:0xf bank_mask:0xf
  v_and_b32_dpp v29, v18, v5 row_newbcast:3 row_mask:0xf bank_mask:0xf
  v_and_b32_dpp v30, v18, v6 row_newbcast:3 row_mask:0xf bank_mask:0xf
  v_and_b32_dpp v31, v18, v7 row_newbcast:3 row_mask:0xf bank_mask:0xf
  v_mfma_f32_16x16x32_bf16 v[36:39], v[228:231], v[32:35], v[36:39]
  s_cmp_ge_i32 s60, 16
  s_cselect_b64 vcc, -1, 0
  s_cmp_ge_i32 s60, -16
  s_cbranch_scc1 L_a_330
  s_waitcnt vmcnt(3)
L_a_330:
  s_cbranch_vccnz L_b_331
  s_waitcnt vmcnt(4)
L_b_331:
  s_waitcnt vmcnt(6)
  buffer_load_dwordx4 v[60:63], v1, s[48:51], s14 offen nt
  v_add_u32 v1, s61, v1
  v_and_b32_dpp v32, v18, v4 row_newbcast:11 row_mask:0xf bank_mask:0xf
  v_and_b32_dpp v33, v18, v5 row_newbcast:11 row_mask:0xf bank_mask:0xf
  v_and_b32_dpp v34, v18, v6 row_newbcast:11 row_mask:0xf bank_mask:0xf
  v_and_b32_dpp v35, v18, v7 row_newbcast:11 row_mask:0xf bank_mask:0xf
  v_mfma_f32_16x16x32_bf16 v[36:39], v[236:239], v[28:31], v[36:39]
  s_cbranch_scc1 L_a_332
  s_waitcnt vmcnt(3)
L_a_332:
  s_cbranch_vccnz L_b_333
  s_waitcnt vmcnt(4)
L_b_333:
  s_waitcnt vmcnt(6)
  buffer_load_dwordx4 v[64:67], v1, s[48:51], s14 offen nt
  v_add_u32 v1, s61, v1
  v_and_b32_dpp v28, v18, v4 row_newbcast:7 row_mask:0xf bank_mask:0xf
  v_and_b32_dpp v29, v18, v5 row_newbcast:7 row_mask:0xf bank_mask:0xf
  v_and_b32_dpp v30, v18, v6 row_newbcast:7 row_mask:0xf bank_mask:0xf
  v_and_b32_dpp v31, v18, v7 row_newbcast:7 row_mask:0xf bank_mask:0xf
  v_mfma_f32_16x16x32_bf16 v[36:39], v[240:243], v[32:35], v[36:39]
  s_cbranch_scc1 L_a_334
  s_waitcnt vmcnt(3)
L_a_334:
  s_cbranch_vccnz L_b_335
  s_waitcnt vmcnt(4)
L_b_335:
  s_waitcnt vmcnt(6)
  buffer_load_dwordx4 v[68:71], v1, s[48:51], s14 offen nt
  v_add_u32 v1, s61, v1
  v_and_b32_dpp v32, v18, v4 row_newbcast:15 row_mask:0xf bank_mask:0xf
  v_and_b32_dpp v33, v18, v5 row_newbcast:15 row_mask:0xf bank_mask:0xf
  v_and_b32_dpp v34, v18, v6 row_newbcast:15 row_mask:0xf bank_mask:0xf
  v_and_b32_dpp v35, v18, v7 row_newbcast:15 row_mask:0xf bank_mask:0xf
  v_mfma_f32_16x16x32_bf16 v[36:39], v[244:247], v[28:31], v[36:39]
  s_cmp_ge_i32 s60, 20
  s_cselect_b64 vcc, -1, 0
  s_cmp_ge_i32 s60, -20
  s_cbranch_scc1 L_a_336
  s_waitcnt vmcnt(3)
L_a_336:
  s_cbranch_vccnz L_b_337
  s_waitcnt vmcnt(4)
L_b_337:
  s_waitcnt vmcnt(6)
  buffer_load_dwordx4 v[72:75], v1, s[48:51], s14 offen nt
  v_add_u32 v1, s61, v1
  v_and_b32_dpp v28, v19, v4 row_newbcast:0 row_mask:0xf bank_mask:0xf
  v_and_b32_dpp v29, v19, v5 row_newbcast:0 row_mask:0xf bank_mask:0xf
  v_and_b32_dpp v30, v19, v6 row_newbcast:0 row_mask:0xf bank_mask:0xf
  v_and_b32_dpp v31, v19, v7 row_newbcast:0 row_mask:0xf bank_mask:0xf
  v_mfma_f32_16x16x32_bf16 v[36:39], v[248:251], v[32:35], v[36:39]
  s_cbranch_scc1 L_a_338
  s_waitcnt vmcnt(3)
L_a_338:
  s_cbranch_vccnz L_b_339
  s_waitcnt vmcnt(4)
L_b_339:
  s_waitcnt vmcnt(6)
  buffer_load_dwordx4 v[76:79], v1, s[48:51], s14 offen nt
  v_add_u32 v1, s61, v1
  v_and_b32_dpp v32, v19, v4 row_newbcast:8 row_mask:0xf bank_mask:0xf
  v_and_b32_dpp v33, v19, v5 row_newbcast:8 row_mask:0xf bank_mask:0xf
  v_and_b32_dpp v34, v19, v6 row_newbcast:8 row_mask:0xf bank_mask:0xf
  v_and_b32_dpp v35, v19, v7 row_newbcast:8 row_mask:0xf bank_mask:0xf
  v_mfma_f32_16x16x32_bf16 v[36:39], v[48:51], v[28:31], v[36:39]
  s_cbranch_scc1 L_a_340
  s_waitcnt vmcnt(3)
L_a_340:
  s_cbranch_vccnz L_b_341
  s_waitcnt vmcnt(4)
L_b_341:
  s_waitcnt vmcnt(6)
  buffer_load_dwordx4 v[80:83], v1, s[48:51], s14 offen nt
  v_add_u32 v1, s61, v1
  v_and_b32_dpp v28, v19, v4 row_newbcast:4 row_mask:0xf bank_mask:0xf
  v_and_b32_dpp v29, v19, v5 row_newbcast:4 row_mask:0xf bank_mask:0xf
  v_and_b32_dpp v30, v19, v6 row_newbcast:4 row_mask:0xf bank_mask:0xf
  v_and_b32_dpp v31, v19, v7 row_newbcast:4 row_mask:0xf bank_mask:0xf
  v_mfma_f32_16x16x32_bf16 v[36:39], v[52:55], v[32:35], v[36:39]
  s_cmp_ge_i32 s60, 24
  s_cselect_b64 vcc, -1, 0
  s_cmp_ge_i32 s60, -24
  s_cbranch_scc1 L_a_342
  s_waitcnt vmcnt(3)
L_a_342:
  s_cbranch_vccnz L_b_343
  s_waitcnt vmcnt(4)
L_b_343:
  s_waitcnt vmcnt(6)
  buffer_load_dwordx4 v[84:87], v1, s[48:51], s14 offen nt
  v_add_u32 v1, s61, v1
  v_and_b32_dpp v32, v19, v4 row_newbcast:12 row_mask:0xf bank_mask:0xf
  v_and_b32_dpp v33, v19, v5 row_newbcast:12 row_mask:0xf bank_mask:0xf
  v_and_b32_dpp v34, v19, v6 row_newbcast:12 row_mask:0xf bank_mask:0xf
  v_and_b32_dpp v35, v19, v7 row_newbcast:12 row_mask:0xf bank_mask:0xf
  v_mfma_f32_16x16x32_bf16 v[36:39], v[56:59], v[28:31], v[36:39]
  s_cbranch_scc1 L_a_344
  s_waitcnt vmcnt(3)
L_a_344:
  s_cbranch_vccnz L_b_345
  s_waitcnt vmcnt(4)
L_b_345:
  s_waitcnt vmcnt(6)
  buffer_load_dwordx4 v[88:91], v1, s[48:51], s14 offen nt
  v_add_u32 v1, s61, v1
  v_and_b32_dpp v28, v19, v4 row_newbcast:1 row_mask:0xf bank_mask:0xf
  v_and_b32_dpp v29, v19, v5 row_newbcast:1 row_mask:0xf bank_mask:0xf
  v_and_b32_dpp v30, v19, v6 row_newbcast:1 row_mask:0xf bank_mask:0xf
  v_and_b32_dpp v31, v19, v7 row_newbcast:1 row_mask:0xf bank_mask:0xf
  v_mfma_f32_16x16x32_bf16 v[36:39], v[60:63], v[32:35], v[36:39]
  s_cbranch_scc1 L_a_346
  s_waitcnt vmcnt(3)
L_a_346:
  s_cbranch_vccnz L_b_347
  s_waitcnt vmcnt(4)
L_b_347:
  s_waitcnt vmcnt(6)
  buffer_load_dwordx4 v[92:95], v1, s[48:51], s14 offen nt
  v_add_u32 v1, s61, v1
  v_and_b32_dpp v32, v19, v4 row_newbcast:9 row_mask:0xf bank_mask:0xf
  v_and_b32_dpp v33, v19, v5 row_newbcast:9 row_mask:0xf bank_mask:0xf
  v_and_b32_dpp v34, v19, v6 row_newbcast:9 row_mask:0xf bank_mask:0xf
  v_and_b32_dpp v35, v19, v7 row_newbcast:9 row_mask:0xf bank_mask:0xf
  v_mfma_f32_16x16x32_bf16 v[36:39], v[64:67], v[28:31], v[36:39]
  s_cmp_ge_i32 s60, 28
  s_cselect_b64 vcc, -1, 0
  s_cmp_ge_i32 s60, -28
  s_cbranch_scc1 L_a_348
  s_waitcnt vmcnt(3)
L_a_348:
  s_cbranch_vccnz L_b_349
  s_waitcnt vmcnt(4)
L_b_349:
  s_waitcnt vmcnt(6)
  buffer_load_dwordx4 v[96:99], v1, s[48:51], s14 offen nt
  v_add_u32 v1, s61, v1
  v_and_b32_dpp v28, v19, v4 row_newbcast:5 row_mask:0xf bank_mask:0xf
  v_and_b32_dpp v29, v19, v5 row_newbcast:5 row_mask:0xf bank_mask:0xf
  v_and_b32_dpp v30, v19, v6 row_newbcast:5 row_mask:0xf bank_mask:0xf
  v_and_b32_dpp v31, v19, v7 row_newbcast:5 row_mask:0xf bank_mask:0xf
  v_mfma_f32_16x16x32_bf16 v[36:39], v[68:71], v[32:35], v[36:39]
  s_cbranch_scc1 L_a_350
  s_waitcnt vmcnt(3)
L_a_350:
  s_cbranch_vccnz L_b_351
  s_waitcnt vmcnt(4)
L_b_351:
  s_waitcnt vmcnt(6)
  buffer_load_dwordx4 v[132:135], v1, s[48:51], s14 offen nt
  v_add_u32 v1, s61, v1
  v_and_b32_dpp v32, v19, v4 row_newbcast:13 row_mask:0xf bank_mask:0xf
  v_and_b32_dpp v33, v19, v5 row_newbcast:13 row_mask:0xf bank_mask:0xf
  v_and_b32_dpp v34, v19, v6 row_newbcast:13 row_mask:0xf bank_mask:0xf
  v_and_b32_dpp v35, v19, v7 row_newbcast:13 row_mask:0xf bank_mask:0xf
  v_mfma_f32_16x16x32_bf16 v[36:39], v[72:75], v[28:31], v[36:39]
  s_cbranch_scc1 L_a_352
  s_waitcnt vmcnt(3)
L_a_352:
  s_cbranch_vccnz L_b_353
  s_waitcnt vmcnt(4)
L_b_353:
  s_waitcnt vmcnt(6)
  buffer_load_dwordx4 v[152:155], v1, s[48:51], s14 offen nt
  v_add_u32 v1, s61, v1
  v_and_b32_dpp v28, v19, v4 row_newbcast:2 row_mask:0xf bank_mask:0xf
  v_and_b32_dpp v29, v19, v5 row_newbcast:2 row_mask:0xf bank_mask:0xf
  v_and_b32_dpp v30, v19, v6 row_newbcast:2 row_mask:0xf bank_mask:0xf
  v_and_b32_dpp v31, v19, v7 row_newbcast:2 row_mask:0xf bank_mask:0xf
  v_mfma_f32_16x16x32_bf16 v[36:39], v[76:79], v[32:35], v[36:39]
  s_cmp_ge_i32 s60, 32
  s_cselect_b64 vcc, -1, 0
  s_cmp_ge_i32 s60, -32
  s_cbranch_scc1 L_a_354
  s_waitcnt vmcnt(3)
L_a_354:
  s_cbranch_vccnz L_b_355
  s_waitcnt vmcnt(4)
L_b_355:
  s_waitcnt vmcnt(6)
  buffer_load_dwordx4 v[172:175], v1, s[48:51], s14 offen nt
  v_and_b32_dpp v32, v19, v4 row_newbcast:10 row_mask:0xf bank_mask:0xf
  v_and_b32_dpp v33, v19, v5 row_newbcast:10 row_mask:0xf bank_mask:0xf
  v_and_b32_dpp v34, v19, v6 row_newbcast:10 row_mask:0xf bank_mask:0xf
  v_and_b32_dpp v35, v19, v7 row_newbcast:10 row_mask:0xf bank_mask:0xf
  v_mfma_f32_16x16x32_bf16 v[36:39], v[80:83], v[28:31], v[36:39]
  v_and_b32_dpp v28, v19, v4 row_newbcast:6 row_mask:0xf bank_mask:0xf
  v_and_b32_dpp v29, v19, v5 row_newbcast:6 row_mask:0xf bank_mask:0xf
  v_and_b32_dpp v30, v19, v6 row_newbcast:6 row_mask:0xf bank_mask:0xf
  v_and_b32_dpp v31, v19, v7 row_newbcast:6 row_mask:0xf bank_mask:0xf
  s_waitcnt vmcnt(6)
  v_mfma_f32_16x16x32_bf16 v[36:39], v[84:87], v[32:35], v[36:39]
  v_and_b32_dpp v32, v19, v4 row_newbcast:14 row_mask:0xf bank_mask:0xf
  v_and_b32_dpp v33, v19, v5 row_newbcast:14 row_mask:0xf bank_mask:0xf
  v_and_b32_dpp v34, v19, v6 row_newbcast:14 row_mask:0xf bank_mask:0xf
  v_and_b32_dpp v35, v19, v7 row_newbcast:14 row_mask:0xf bank_mask:0xf
  s_waitcnt vmcnt(5)
  v_mfma_f32_16x16x32_bf16 v[36:39], v[88:91], v[28:31], v[36:39]
  v_and_b32_dpp v28, v19, v4 row_newbcast:3 row_mask:0xf bank_mask:0xf
  v_and_b32_dpp v29, v19, v5 row_newbcast:3 row_mask:0xf bank_mask:0xf
  v_and_b32_dpp v30, v19, v6 row_newbcast:3 row_mask:0xf bank_mask:0xf
  v_and_b32_dpp v31, v19, v7 row_newbcast:3 row_mask:0xf bank_mask:0xf
  s_waitcnt vmcnt(4)
  v_mfma_f32_16x16x32_bf16 v[36:39], v[92:95], v[32:35], v[36:39]
  v_and_b32_dpp v32, v19, v4 row_newbcast:11 row_mask:0xf bank_mask:0xf
  v_and_b32_dpp v33, v19, v5 row_newbcast:11 row_mask:0xf bank_mask:0xf
  v_and_b32_dpp v34, v19, v6 row_newbcast:11 row_mask:0xf bank_mask:0xf
  v_and_b32_dpp v35, v19, v7 row_newbcast:11 row_mask:0xf bank_mask:0xf
  s_waitcnt vmcnt(3)
  v_mfma_f32_16x16x32_bf16 v[36:39], v[96:99], v[28:31], v[36:39]
  v_and_b32_dpp v28, v19, v4 row_newbcast:7 row_mask:0xf bank_mask:0xf
  v_and_b32_dpp v29, v19, v5 row_newbcast:7 row_mask:0xf bank_mask:0xf
  v_and_b32_dpp v30, v19, v6 row_newbcast:7 row_mask:0xf bank_mask:0xf
  v_and_b32_dpp v31, v19, v7 row_newbcast:7 row_mask:0xf bank_mask:0xf
  s_waitcnt vmcnt(2)
  v_mfma_f32_16x16x32_bf16 v[36:39], v[132:135], v[32:35], v[36:39]
  v_and_b32_dpp v32, v19, v4 row_newbcast:15 row_mask:0xf bank_mask:0xf
  v_and_b32_dpp v33, v19, v5 row_newbcast:15 row_mask:0xf bank_mask:0xf
  v_and_b32_dpp v34, v19, v6 row_newbcast:15 row_mask:0xf bank_mask:0xf
  v_and_b32_dpp v35, v19, v7 row_newbcast:15 row_mask:0xf bank_mask:0xf
  s_waitcnt vmcnt(1)
  v_mfma_f32_16x16x32_bf16 v[36:39], v[152:155], v[28:31], v[36:39]
  s_nop 0
  s_waitcnt vmcnt(0)
  v_mfma_f32_16x16x32_bf16 v[36:39], v[172:175], v[32:35], v[36:39]
  s_nop 7
  v_and_b32 v40, v25, v36
  v_and_b32 v41, v25, v37
  v_and_b32 v42, v25, v38
  v_and_b32 v43, v25, v39
  v_sub_f32 v40, v36, v40
  v_sub_f32 v41, v37, v41
  v_sub_f32 v42, v38, v42
  v_sub_f32 v43, v39, v43
  v_perm_b32 v44, v41, v40, s69
  v_perm_b32 v45, v43, v42, s69
  ds_write_b64 v24, v[44:45] offset:512
  s_waitcnt lgkmcnt(0)
  s_barrier
  s_endpgm
L_helper:
  s_setprio 3
  v_and_b32 v1, 15, v0
  v_lshrrev_b32 v2, 4, v0
  v_mov_b32 v3, 0
  v_mov_b32 v5, 0
  s_mov_b32 s68, 0x05040100
  s_mov_b32 s69, 0x07060302
  v_lshlrev_b32 v4, 2, v0
  ds_write_b32 v4, v3
  s_lshr_b32 s12, s2, 5
  s_mov_b32 s100, 0
  s_cmp_eq_u32 s12, 6
  s_cselect_b32 s62, 1, 0
  s_waitcnt lgkmcnt(0)
  s_load_dword s7, s[42:43], 0
  s_mov_b32 s52, s42
  s_mov_b32 s53, s43
  s_mov_b32 s54, 983040
  s_mov_b32 s55, 0x20000
  s_barrier
  s_cmp_eq_u32 s62, 1
  s_cbranch_scc0 L_qprep
  s_and_b32 s10, s2, 7
  s_bfe_u32 s11, s2, 0x20003
  s_lshl_b32 s10, s10, 2
  s_add_u32 s100, s10, s11
L_mod:
  s_mov_b32 s44, s34
  s_mov_b32 s45, s35
  s_mov_b32 s46, 4096
  s_mov_b32 s47, 0x20000
  s_mov_b32 s48, s36
  s_mov_b32 s49, s37
  s_mov_b32 s50, 3145728
  s_mov_b32 s51, 0x20000
  v_lshlrev_b32 v8, 10, v2
  v_lshl_add_u32 v8, v1, 4, v8
  s_lshl_b32 s10, s9, 8
  buffer_load_dwordx4 v[16:19], v8, s[44:47], s10 offen
  v_mul_u32_u24 v9, 49152, v2
  v_lshl_add_u32 v9, v1, 2, v9
  s_mul_i32 s10, s9, 786432
  s_lshl_b32 s11, s100, 6
  s_add_u32 s10, s10, s11
  s_cmp_ge_u32 s100, 32
  s_cbranch_scc1 L_mod2_loads
  buffer_load_dword v64, v9, s[48:51], s10 offen
  s_addk_i32 s10, 6144
  buffer_load_dword v65, v9, s[48:51], s10 offen
  s_addk_i32 s10, 6144
  buffer_load_dword v66, v9, s[48:51], s10 offen
  s_addk_i32 s10, 6144
  buffer_load_dword v67, v9, s[48:51], s10 offen
  s_addk_i32 s10, 6144
  buffer_load_dword v68, v9, s[48:51], s10 offen
  s_addk_i32 s10, 6144
  buffer_load_dword v69, v9, s[48:51], s10 offen
  s_addk_i32 s10, 6144
  buffer_load_dword v70, v9, s[48:51], s10 offen
  s_addk_i32 s10, 6144
  buffer_load_dword v71, v9, s[48:51], s10 offen
  s_add_u32 s10, s10, 153600
  buffer_load_dword v72, v9, s[48:51], s10 offen
  s_addk_i32 s10, 6144
  buffer_load_dword v73, v9, s[48:51], s10 offen
  s_addk_i32 s10, 6144
  buffer_load_dword v74, v9, s[48:51], s10 offen
  s_addk_i32 s10, 6144
  buffer_load_dword v75, v9, s[48:51], s10 offen
  s_addk_i32 s10, 6144
  buffer_load_dword v76, v9, s[48:51], s10 offen
  s_addk_i32 s10, 6144
  buffer_load_dword v77, v9, s[48:51], s10 offen
  s_addk_i32 s10, 6144
  buffer_load_dword v78, v9, s[48:51], s10 offen
  s_addk_i32 s10, 6144
  buffer_load_dword v79, v9, s[48:51], s10 offen
  s_add_u32 s10, s10, 153600
  buffer_load_dword v80, v9, s[48:51], s10 offen
  s_addk_i32 s10, 6144
  buffer_load_dword v81, v9, s[48:51], s10 offen
  s_addk_i32 s10, 6144
  buffer_load_dword v82, v9, s[48:51], s10 offen
  s_addk_i32 s10, 6144
  buffer_load_dword v83, v9, s[48:51], s10 offen
  s_addk_i32 s10, 6144
  buffer_load_dword v84, v9, s[48:51], s10 offen
  s_addk_i32 s10, 6144
  buffer_load_dword v85, v9, s[48:51], s10 offen
  s_addk_i32 s10, 6144
  buffer_load_dword v86, v9, s[48:51], s10 offen
  s_addk_i32 s10, 6144
  buffer_load_dword v87, v9, s[48:51], s10 offen
  s_add_u32 s10, s10, 153600
  buffer_load_dword v88, v9, s[48:51], s10 offen
  s_addk_i32 s10, 6144
  buffer_load_dword v89, v9, s[48:51], s10 offen
  s_addk_i32 s10, 6144
  buffer_load_dword v90, v9, s[48:51], s10 offen
  s_addk_i32 s10, 6144
  buffer_load_dword v91, v9, s[48:51], s10 offen
  s_addk_i32 s10, 6144
  buffer_load_dword v92, v9, s[48:51], s10 offen
  s_addk_i32 s10, 6144
  buffer_load_dword v93, v9, s[48:51], s10 offen
  s_addk_i32 s10, 6144
  buffer_load_dword v94, v9, s[48:51], s10 offen
  s_addk_i32 s10, 6144
  buffer_load_dword v95, v9, s[48:51], s10 offen
  s_lshl_b32 s10, s100, 2
  s_add_u32 s10, s10, s9
  s_add_u32 s56, s42, 69632
  s_addc_u32 s57, s43, 0
  s_mov_b32 s58, 11008
  s_mov_b32 s59, 0x20000
  v_mov_b32 v56, 0
  v_mov_b32 v60, -1
  v_mov_b32 v57, 0
  v_mov_b32 v61, -1
  v_mov_b32 v58, 0
  v_mov_b32 v62, -1
  v_mov_b32 v59, 0
  v_mov_b32 v63, -1
  s_mul_i32 s11, s10, 192
  s_lshl_b32 s14, s10, 5
  s_add_u32 s14, s14, 917504
  s_add_u32 s11, s11, 851968
  v_lshlrev_b32 v8, 4, v0
  s_lshl_b32 s13, s10, 7
  v_add_u32 v9, s13, v8
  s_lshl_b32 s13, s10, 8
  s_add_u32 s13, s13, 786432
  s_mov_b64 exec, 0xfff
  buffer_store_dwordx4 v[56:59], v8, s[52:55], s11 offen sc1
  s_mov_b64 exec, 3
  buffer_store_dwordx4 v[60:63], v8, s[52:55], s14 offen sc1
  s_mov_b64 exec, 0xff
  buffer_store_dwordx4 v[60:63], v9, s[56:59], 0 offen sc1
  s_mov_b64 exec, 1
  buffer_store_dword v3, v3, s[52:55], s13 offen sc1
  s_mov_b64 exec, -1
L_qprep:
  s_mov_b32 s44, s16
  s_mov_b32 s45, s17
  s_mov_b32 s46, 4096
  s_mov_b32 s47, 0x20000
  s_mov_b32 s48, s22
  s_mov_b32 s49, s23
  s_mov_b32 s50, 4194304
  s_mov_b32 s51, 0x20000
  v_lshlrev_b32 v8, 4, v0
  s_lshl_b32 s10, s9, 10
  buffer_load_dwordx4 v[224:227], v8, s[44:47], s10 offen
  s_and_b32 s13, s2, 3
  s_lshl_b32 s13, s13, 2
  s_add_u32 s13, s13, s9
  v_and_b32 v9, 4, v0
  v_lshl_add_u32 v9, v2, 3, v9
  v_and_b32 v6, 3, v0
  v_lshlrev_b32 v10, 10, v6
  v_lshl_add_u32 v10, v9, 1, v10
  s_lshl_b32 s11, s13, 6
  buffer_load_dwordx2 v[228:229], v10, s[44:47], s11 offen
  v_lshlrev_b32 v8, 16, v2
  v_lshl_add_u32 v8, v1, 3, v8
  s_lshl_b32 s10, s13, 18
  s_lshr_b32 s11, s2, 2
  s_lshl_b32 s11, s11, 7
  s_add_u32 s14, s10, s11
  buffer_load_dwordx2 v[128:129], v8, s[48:51], s14 offen nt
  s_addk_i32 s14, 0x2000
  buffer_load_dwordx2 v[130:131], v8, s[48:51], s14 offen nt
  s_addk_i32 s14, 0x2000
  buffer_load_dwordx2 v[132:133], v8, s[48:51], s14 offen nt
  s_addk_i32 s14, 0x2000
  buffer_load_dwordx2 v[134:135], v8, s[48:51], s14 offen nt
  s_addk_i32 s14, 0x2000
  buffer_load_dwordx2 v[136:137], v8, s[48:51], s14 offen nt
  s_addk_i32 s14, 0x2000
  buffer_load_dwordx2 v[138:139], v8, s[48:51], s14 offen nt
  s_addk_i32 s14, 0x2000
  buffer_load_dwordx2 v[140:141], v8, s[48:51], s14 offen nt
  s_addk_i32 s14, 0x2000
  buffer_load_dwordx2 v[142:143], v8, s[48:51], s14 offen nt
  v_bfe_u32 v10, v0, 3, 1
  v_lshlrev_b32 v10, 9, v10
  v_add_lshl_u32 v9, v9, v10, 2
  v_lshl_add_u32 v5, v6, 12, v9
  s_lshl_b32 s101, s13, 7
  s_bfe_u32 s10, s2, 0x10002
  s_lshl_b32 s10, s10, 14
  s_add_u32 s101, s101, s10
  s_add_u32 s101, s101, 655360
  s_waitcnt lgkmcnt(0)
  s_add_u32 s7, s7, 0x9e3779b9
  s_cmp_eq_u32 s62, 1
  s_cbranch_scc0 L_qphase
L_mod_loaded:
  s_waitcnt vmcnt(46)
  v_lshlrev_b32 v20, 16, v16
  v_and_b32 v21, s70, v16
  v_lshlrev_b32 v22, 16, v17
  v_and_b32 v23, s70, v17
  v_lshlrev_b32 v24, 16, v18
  v_and_b32 v25, s70, v18
  v_lshlrev_b32 v26, 16, v19
  v_and_b32 v27, s70, v19
  s_mov_b32 s10, 0xbfb8aa3b
  s_mov_b32 s11, 0x7f7fffff
  v_mul_f32 v32, s10, v20
  v_mul_f32 v33, s10, v21
  v_mul_f32 v34, s10, v22
  v_mul_f32 v35, s10, v23
  v_mul_f32 v36, s10, v24
  v_mul_f32 v37, s10, v25
  v_mul_f32 v38, s10, v26
  v_mul_f32 v39, s10, v27
  v_exp_f32 v32, v32
  v_exp_f32 v33, v33
  v_exp_f32 v34, v34
  v_exp_f32 v35, v35
  v_exp_f32 v36, v36
  v_exp_f32 v37, v37
  v_exp_f32 v38, v38
  v_exp_f32 v39, v39
  v_add_f32 v32, 1.0, v32
  v_add_f32 v33, 1.0, v33
  v_add_f32 v34, 1.0, v34
  v_add_f32 v35, 1.0, v35
  v_add_f32 v36, 1.0, v36
  v_add_f32 v37, 1.0, v37
  v_add_f32 v38, 1.0, v38
  v_add_f32 v39, 1.0, v39
  v_rcp_f32 v40, v32
  v_rcp_f32 v41, v33
  v_rcp_f32 v42, v34
  v_rcp_f32 v43, v35
  v_rcp_f32 v44, v36
  v_rcp_f32 v45, v37
  v_rcp_f32 v46, v38
  v_rcp_f32 v47, v39
  v_min_f32 v32, s11, v32
  v_min_f32 v33, s11, v33
  v_min_f32 v34, s11, v34
  v_min_f32 v35, s11, v35
  v_min_f32 v36, s11, v36
  v_min_f32 v37, s11, v37
  v_min_f32 v38, s11, v38
  v_min_f32 v39, s11, v39
  v_mul_f32 v48, v20, v40
  v_mul_f32 v49, v21, v41
  v_mul_f32 v50, v22, v42
  v_mul_f32 v51, v23, v43
  v_mul_f32 v52, v24, v44
  v_mul_f32 v53, v25, v45
  v_mul_f32 v54, v26, v46
  v_mul_f32 v55, v27, v47
  v_fma_f32 v32, -v48, v32, v20
  v_fma_f32 v33, -v49, v33, v21
  v_fma_f32 v34, -v50, v34, v22
  v_fma_f32 v35, -v51, v35, v23
  v_fma_f32 v36, -v52, v36, v24
  v_fma_f32 v37, -v53, v37, v25
  v_fma_f32 v38, -v54, v38, v26
  v_fma_f32 v39, -v55, v39, v27
  v_fmac_f32 v48, v32, v40
  v_fmac_f32 v49, v33, v41
  v_fmac_f32 v50, v34, v42
  v_fmac_f32 v51, v35, v43
  v_fmac_f32 v52, v36, v44
  v_fmac_f32 v53, v37, v45
  v_fmac_f32 v54, v38, v46
  v_fmac_f32 v55, v39, v47
  v_cvt_pk_bf16_f32 v16, v48, v49
  v_cvt_pk_bf16_f32 v17, v50, v51
  v_cvt_pk_bf16_f32 v18, v52, v53
  v_cvt_pk_bf16_f32 v19, v54, v55
  s_mul_i32 s10, s9, 1088
  v_mul_u32_u24 v8, 272, v2
  v_lshl_add_u32 v8, v1, 4, v8
  v_add_u32 v8, s10, v8
  ds_write_b128 v8, v[16:19] offset:2816
  v_and_b32 v8, 3, v0
  v_mul_u32_u24 v8, 272, v8
  v_lshl_add_u32 v8, v2, 4, v8
  v_add_u32 v8, s10, v8
  s_waitcnt lgkmcnt(0)
  ds_read_b128 v[16:19], v8 offset:2816
  ds_read_b128 v[20:23], v8 offset:2880
  ds_read_b128 v[24:27], v8 offset:2944
  ds_read_b128 v[28:31], v8 offset:3008
  s_lshl_b32 s10, s9, 9
  v_lshlrev_b32 v8, 4, v1
  v_add_u32 v9, s10, v8
  v_mov_b32 v10, 1
  s_waitcnt vmcnt(38) lgkmcnt(0)
  v_perm_b32 v96, v65, v64, s68
  v_perm_b32 v97, v67, v66, s68
  v_perm_b32 v98, v69, v68, s68
  v_perm_b32 v99, v71, v70, s68
  v_perm_b32 v100, v65, v64, s69
  v_perm_b32 v101, v67, v66, s69
  v_perm_b32 v102, v69, v68, s69
  v_perm_b32 v103, v71, v70, s69
  v_mfma_f32_16x16x32_bf16 v[32:35], v[16:19], v[96:99], 0
  s_nop 0
  v_mfma_f32_16x16x32_bf16 v[36:39], v[16:19], v[100:103], 0
  s_waitcnt vmcnt(30) lgkmcnt(0)
  v_perm_b32 v104, v73, v72, s68
  v_perm_b32 v105, v75, v74, s68
  v_perm_b32 v106, v77, v76, s68
  v_perm_b32 v107, v79, v78, s68
  v_perm_b32 v108, v73, v72, s69
  v_perm_b32 v109, v75, v74, s69
  v_perm_b32 v110, v77, v76, s69
  v_perm_b32 v111, v79, v78, s69
  v_mfma_f32_16x16x32_bf16 v[32:35], v[20:23], v[104:107], v[32:35]
  s_nop 0
  v_mfma_f32_16x16x32_bf16 v[36:39], v[20:23], v[108:111], v[36:39]
  s_waitcnt vmcnt(22) lgkmcnt(0)
  v_perm_b32 v112, v81, v80, s68
  v_perm_b32 v113, v83, v82, s68
  v_perm_b32 v114, v85, v84, s68
  v_perm_b32 v115, v87, v86, s68
  v_perm_b32 v116, v81, v80, s69
  v_perm_b32 v117, v83, v82, s69
  v_perm_b32 v118, v85, v84, s69
  v_perm_b32 v119, v87, v86, s69
  v_mfma_f32_16x16x32_bf16 v[32:35], v[24:27], v[112:115], v[32:35]
  s_nop 0
  v_mfma_f32_16x16x32_bf16 v[36:39], v[24:27], v[116:119], v[36:39]
  s_waitcnt vmcnt(14) lgkmcnt(0)
  v_perm_b32 v120, v89, v88, s68
  v_perm_b32 v121, v91, v90, s68
  v_perm_b32 v122, v93, v92, s68
  v_perm_b32 v123, v95, v94, s68
  v_perm_b32 v124, v89, v88, s69
  v_perm_b32 v125, v91, v90, s69
  v_perm_b32 v126, v93, v92, s69
  v_perm_b32 v127, v95, v94, s69
  v_mfma_f32_16x16x32_bf16 v[32:35], v[28:31], v[120:123], v[32:35]
  s_nop 0
  v_mfma_f32_16x16x32_bf16 v[36:39], v[28:31], v[124:127], v[36:39]
  s_mov_b64 exec, 0xffff
  s_nop 4
  ds_write_b128 v9, v[32:35] offset:7168
  s_nop 0
  ds_write_b128 v9, v[36:39] offset:7424
  s_mov_b64 exec, 1
  s_waitcnt vmcnt(10) lgkmcnt(0)
  ds_add_rtn_u32 v10, v3, v10 offset:12
  s_mov_b64 exec, -1
  v_lshl_add_u32 v8, v2, 2, v8
  v_mul_u32_u24 v9, 12288, v2
  v_lshl_add_u32 v9, v1, 3, v9
  v_mov_b32 v11, s7
  s_waitcnt lgkmcnt(0)
  v_readfirstlane_b32 s10, v10
  s_cmp_eq_u32 s10, 3
  s_cbranch_scc0 L_mod_done
  ds_read2st64_b32 v[32:33], v8 offset0:28 offset1:29
  ds_read2st64_b32 v[34:35], v8 offset0:30 offset1:31
  ds_read2st64_b32 v[36:37], v8 offset0:32 offset1:33
  ds_read2st64_b32 v[38:39], v8 offset0:34 offset1:35
  s_lshl_b32 s10, s100, 7
  s_add_u32 s11, s10, 655360
  s_add_u32 s10, s10, 81920
  v_lshlrev_b32 v12, 12, v2
  v_lshl_add_u32 v12, v1, 3, v12
  s_waitcnt lgkmcnt(0)
  v_add_f32 v32, v32, v34
  v_add_f32 v36, v36, v38
  v_add_f32 v33, v33, v35
  v_add_f32 v37, v37, v39
  v_add_f32 v32, v32, v36
  v_add_f32 v33, v33, v37
  v_cvt_pk_bf16_f32 v10, v32, v33
  s_cmp_ge_u32 s100, 32
  s_cbranch_scc1 L_mod2_pub
  buffer_store_dwordx2 v[10:11], v12, s[52:55], s11 offen sc1
  s_addk_i32 s11, 0x4000
  buffer_store_dwordx2 v[10:11], v12, s[52:55], s11 offen sc1
L_mod_done:
  s_cmp_ge_u32 s100, 32
  s_cbranch_scc1 L_after_mod2
L_qphase:
  s_waitcnt vmcnt(9)
  v_lshlrev_b32 v20, 16, v224
  v_and_b32 v21, s70, v224
  v_lshlrev_b32 v22, 16, v225
  v_and_b32 v23, s70, v225
  v_lshlrev_b32 v24, 16, v226
  v_and_b32 v25, s70, v226
  v_lshlrev_b32 v26, 16, v227
  v_and_b32 v27, s70, v227
  v_add_f32 v10, v20, v21
  v_add_f32 v12, v22, v23
  v_add_f32 v11, v24, v25
  v_add_f32 v10, v10, v26
  v_add_f32 v12, v12, v27
  v_add_f32 v10, v10, v11
  v_add_f32 v10, v10, v12
  s_nop 1
  v_add_f32_dpp v10, v10, v10 row_ror:8 row_mask:0xf bank_mask:0xf
  s_nop 1
  v_add_f32_dpp v10, v10, v10 row_ror:4 row_mask:0xf bank_mask:0xf
  s_nop 1
  v_add_f32_dpp v10, v10, v10 row_ror:2 row_mask:0xf bank_mask:0xf
  s_nop 1
  v_add_f32_dpp v10, v10, v10 row_ror:1 row_mask:0xf bank_mask:0xf
  s_nop 0
  v_readlane_b32 s10, v10, 0
  v_readlane_b32 s11, v10, 16
  v_readlane_b32 s12, v10, 32
  v_readlane_b32 s13, v10, 48
  v_mov_b32 v10, s10
  v_add_f32 v10, s11, v10
  v_add_f32 v10, s12, v10
  v_add_f32 v10, s13, v10
  v_mul_f32 v10, 0x3b000000, v10
  v_sub_f32 v12, v20, v10
  v_mul_f32 v11, v12, v12
  v_sub_f32 v12, v21, v10
  v_fmac_f32 v11, v12, v12
  v_sub_f32 v12, v22, v10
  v_fmac_f32 v11, v12, v12
  v_sub_f32 v12, v23, v10
  v_fmac_f32 v11, v12, v12
  v_sub_f32 v12, v24, v10
  v_fmac_f32 v11, v12, v12
  v_sub_f32 v12, v25, v10
  v_fmac_f32 v11, v12, v12
  v_sub_f32 v12, v26, v10
  v_fmac_f32 v11, v12, v12
  v_sub_f32 v12, v27, v10
  v_fmac_f32 v11, v12, v12
  s_nop 1
  v_add_f32_dpp v11, v11, v11 row_ror:8 row_mask:0xf bank_mask:0xf
  s_nop 1
  v_add_f32_dpp v11, v11, v11 row_ror:4 row_mask:0xf bank_mask:0xf
  s_nop 1
  v_add_f32_dpp v11, v11, v11 row_ror:2 row_mask:0xf bank_mask:0xf
  s_nop 1
  v_add_f32_dpp v11, v11, v11 row_ror:1 row_mask:0xf bank_mask:0xf
  s_nop 0
  v_readlane_b32 s10, v11, 0
  v_readlane_b32 s11, v11, 16
  v_readlane_b32 s12, v11, 32
  v_readlane_b32 s13, v11, 48
  v_mov_b32 v11, s10
  v_add_f32 v11, s11, v11
  v_add_f32 v11, s12, v11
  v_add_f32 v11, s13, v11
  v_mul_f32 v11, 0x3b000000, v11
  v_cvt_pk_bf16_f32 v12, v10, v11
  v_lshlrev_b32 v10, 16, v12
  v_and_b32 v11, s70, v12
  v_add_f32 v11, 0x3727c5ac, v11
  v_cvt_pk_bf16_f32 v11, v11, v11
  v_and_b32 v11, s70, v11
  v_sqrt_f32 v11, v11
  s_nop 0
  v_cvt_pk_bf16_f32 v11, v11, v11
  v_and_b32 v11, s70, v11
  v_rcp_f32 v11, v11
  s_nop 0
  s_lshl_b32 s10, s9, 3
  v_mov_b32 v12, s10
  v_mov_b32 v13, 1
  s_mov_b64 exec, 1
  ds_write_b64 v12, v[10:11] offset:64
  s_waitcnt lgkmcnt(0)
  ds_add_u32 v3, v13 offset:4
  s_mov_b64 exec, -1
  s_waitcnt vmcnt(0)
  v_perm_b32 v144, v130, v128, s68
  v_perm_b32 v148, v130, v128, s69
  v_perm_b32 v145, v134, v132, s68
  v_perm_b32 v149, v134, v132, s69
  v_perm_b32 v146, v138, v136, s68
  v_perm_b32 v150, v138, v136, s69
  v_perm_b32 v147, v142, v140, s68
  v_perm_b32 v151, v142, v140, s69
  v_perm_b32 v152, v131, v129, s68
  v_perm_b32 v156, v131, v129, s69
  v_perm_b32 v153, v135, v133, s68
  v_perm_b32 v157, v135, v133, s69
  v_perm_b32 v154, v139, v137, s68
  v_perm_b32 v158, v139, v137, s69
  v_perm_b32 v155, v143, v141, s68
  v_perm_b32 v159, v143, v141, s69
L_lw_1:
  ds_read_b32 v12, v3 offset:4
  s_waitcnt lgkmcnt(0)
  v_readfirstlane_b32 s10, v12
  s_cmp_ge_u32 s10, 4
  s_cbranch_scc1 L_lwd_2
  s_sleep 1
  s_add_u32 s8, s8, 1
  s_cmp_lt_u32 s8, 262144
  s_cbranch_scc1 L_lw_1
L_lwd_2:
  v_lshlrev_b32 v12, 3, v6
  ds_read_b64 v[10:11], v12 offset:64
  v_lshlrev_b32 v12, 16, v228
  v_and_b32 v13, s70, v228
  v_lshlrev_b32 v14, 16, v229
  v_and_b32 v15, s70, v229
  s_waitcnt lgkmcnt(0)
  v_sub_f32 v12, v12, v10
  v_sub_f32 v13, v13, v10
  v_sub_f32 v14, v14, v10
  v_sub_f32 v15, v15, v10
  v_cvt_pk_bf16_f32 v16, v12, v13
  v_lshlrev_b32 v12, 16, v16
  v_and_b32 v13, s70, v16
  v_cvt_pk_bf16_f32 v16, v14, v15
  v_lshlrev_b32 v14, 16, v16
  v_and_b32 v15, s70, v16
  v_mul_f32 v12, v12, v11
  v_mul_f32 v13, v13, v11
  v_mul_f32 v14, v14, v11
  v_mul_f32 v15, v15, v11
  v_cvt_pk_bf16_f32 v16, v12, v13
  v_lshlrev_b32 v12, 16, v16
  v_and_b32 v13, s70, v16
  v_cvt_pk_bf16_f32 v16, v14, v15
  v_lshlrev_b32 v14, 16, v16
  v_and_b32 v15, s70, v16
  s_lshl_b32 s10, s9, 10
  v_lshlrev_b32 v25, 4, v1
  v_add_u32 v24, s10, v25
  v_lshl_add_u32 v25, v2, 2, v25
  v_lshlrev_b32 v26, 17, v2
  v_lshl_add_u32 v26, v1, 4, v26
  s_lshr_b32 s10, s2, 3
  s_lshl_b32 s10, s10, 12
  s_and_b32 s11, s2, 3
  s_lshl_b32 s11, s11, 10
  s_add_u32 s10, s10, s11
  s_bfe_u32 s11, s2, 0x10002
  s_lshl_b32 s11, s11, 9
  s_add_u32 s10, s10, s11
  s_add_u32 s15, s10, 131072
  v_lshlrev_b32 v27, 4, v0
  v_mov_b32 v10, 1
  s_mov_b32 s48, s24
  s_mov_b32 s49, s25
  s_mov_b32 s50, 4194304
  s_mov_b32 s51, 0x20000
  v_lshlrev_b32 v28, 11, v2
  v_lshl_add_u32 v28, v1, 4, v28
  s_lshl_b32 s10, s6, 10
  s_xor_b32 s11, s10, 0x400
  v_add_u32 v29, s11, v28
  v_add_u32 v28, s10, v28
  s_lshl_b32 s10, s4, 17
  s_lshl_b32 s11, s9, 8
  s_add_u32 s63, s10, s11
  s_mov_b32 s64, s5
  s_cmp_eq_u32 s62, 1
  s_cbranch_scc1 L_slot1_done
  s_add_u32 s14, s64, 0
  s_and_b32 s14, s14, 3
  s_lshl_b32 s14, s14, 15
  s_add_u32 s14, s14, s63
  s_waitcnt vmcnt(1)
  buffer_load_dwordx4 v[160:163], v28, s[48:51], s14 offen
  s_addk_i32 s14, 0x2000
  s_waitcnt vmcnt(1)
  buffer_load_dwordx4 v[164:167], v28, s[48:51], s14 offen
  s_addk_i32 s14, 0x2000
  s_waitcnt vmcnt(1)
  buffer_load_dwordx4 v[168:171], v28, s[48:51], s14 offen
  s_addk_i32 s14, 0x2000
  s_waitcnt vmcnt(1)
  buffer_load_dwordx4 v[172:175], v28, s[48:51], s14 offen
  s_addk_i32 s14, -24576
  s_waitcnt vmcnt(1)
  buffer_load_dwordx4 v[176:179], v29, s[48:51], s14 offen
  s_addk_i32 s14, 0x2000
  s_waitcnt vmcnt(1)
  buffer_load_dwordx4 v[180:183], v29, s[48:51], s14 offen
  s_addk_i32 s14, 0x2000
  s_waitcnt vmcnt(1)
  buffer_load_dwordx4 v[184:187], v29, s[48:51], s14 offen
  s_addk_i32 s14, 0x2000
  s_waitcnt vmcnt(1)
  buffer_load_dwordx4 v[188:191], v29, s[48:51], s14 offen
L_slot1_done:
L_mp_3:
  buffer_load_dwordx4 v[48:51], v5, s[52:55], s101 offen sc1
  s_waitcnt vmcnt(0)
  v_cmp_ne_u32 s[10:11], s7, v49
  v_cmp_ne_u32 vcc, s7, v51
  s_or_b64 s[10:11], s[10:11], vcc
  s_cbranch_scc0 L_mpd_4
  s_sleep 24
  s_add_u32 s8, s8, 1
  s_cmp_lt_u32 s8, 262144
  s_cbranch_scc1 L_mp_3
L_mpd_4:
  v_mov_b32_dpp v49, v48 row_ror:8 row_mask:0xf bank_mask:0xf
  v_mov_b32_dpp v51, v50 row_ror:8 row_mask:0xf bank_mask:0xf
  v_lshlrev_b32 v56, 16, v48
  v_and_b32 v57, s70, v48
  v_lshlrev_b32 v58, 16, v50
  v_and_b32 v59, s70, v50
  v_lshlrev_b32 v52, 16, v49
  v_and_b32 v53, s70, v49
  v_lshlrev_b32 v54, 16, v51
  v_and_b32 v55, s70, v51
  v_add_f32 v52, 1.0, v52
  v_add_f32 v53, 1.0, v53
  v_add_f32 v54, 1.0, v54
  v_add_f32 v55, 1.0, v55
  v_cvt_pk_bf16_f32 v48, v52, v53
  v_lshlrev_b32 v52, 16, v48
  v_and_b32 v53, s70, v48
  v_cvt_pk_bf16_f32 v49, v54, v55
  v_lshlrev_b32 v54, 16, v49
  v_and_b32 v55, s70, v49
  v_mul_f32 v52, v52, v12
  v_mul_f32 v53, v53, v13
  v_mul_f32 v54, v54, v14
  v_mul_f32 v55, v55, v15
  v_cvt_pk_bf16_f32 v48, v52, v53
  v_lshlrev_b32 v52, 16, v48
  v_and_b32 v53, s70, v48
  v_cvt_pk_bf16_f32 v49, v54, v55
  v_lshlrev_b32 v54, 16, v49
  v_and_b32 v55, s70, v49
  v_add_f32 v52, v52, v56
  v_add_f32 v53, v53, v57
  v_add_f32 v54, v54, v58
  v_add_f32 v55, v55, v59
  v_cvt_pk_bf16_f32 v16, v52, v53
  v_cvt_pk_bf16_f32 v17, v54, v55
  s_nop 0
  v_mov_b32_dpp v18, v16 row_shl:4 row_mask:0xf bank_mask:0xf
  v_mov_b32_dpp v19, v17 row_shl:4 row_mask:0xf bank_mask:0xf
  s_nop 1
  v_mfma_f32_16x16x32_bf16 v[32:35], v[16:19], v[144:147], 0
  v_mfma_f32_16x16x32_bf16 v[36:39], v[16:19], v[148:151], 0
  v_mfma_f32_16x16x32_bf16 v[40:43], v[16:19], v[152:155], 0
  v_mfma_f32_16x16x32_bf16 v[44:47], v[16:19], v[156:159], 0
  s_mov_b64 exec, 0xffff
  s_nop 3
  ds_write_b128 v24, v[32:35] offset:11264
  ds_write_b128 v24, v[36:39] offset:11520
  ds_write_b128 v24, v[40:43] offset:11776
  ds_write_b128 v24, v[44:47] offset:12032
  s_mov_b64 exec, 1
  s_waitcnt lgkmcnt(0)
  ds_add_rtn_u32 v10, v3, v10 offset:8
  s_mov_b64 exec, -1
  s_waitcnt lgkmcnt(0)
  v_readfirstlane_b32 s12, v10
  s_cmp_eq_u32 s12, 3
  s_cbranch_scc0 L_q_nopub
  ds_read2st64_b32 v[32:33], v25 offset0:44 offset1:45
  ds_read2st64_b32 v[34:35], v25 offset0:46 offset1:47
  ds_read2st64_b32 v[36:37], v25 offset0:48 offset1:49
  ds_read2st64_b32 v[38:39], v25 offset0:50 offset1:51
  ds_read2st64_b32 v[40:41], v25 offset0:52 offset1:53
  ds_read2st64_b32 v[42:43], v25 offset0:54 offset1:55
  ds_read2st64_b32 v[44:45], v25 offset0:56 offset1:57
  ds_read2st64_b32 v[46:47], v25 offset0:58 offset1:59
  v_mov_b32 v49, s7
  v_mov_b32 v51, s7
  v_mov_b32 v53, s7
  v_mov_b32 v55, s7
  s_waitcnt lgkmcnt(0)
  v_add_f32 v32, v32, v36
  v_add_f32 v40, v40, v44
  v_add_f32 v33, v33, v37
  v_add_f32 v41, v41, v45
  v_add_f32 v34, v34, v38
  v_add_f32 v42, v42, v46
  v_add_f32 v35, v35, v39
  v_add_f32 v43, v43, v47
  v_add_f32 v48, v32, v40
  v_add_f32 v50, v33, v41
  v_add_f32 v52, v34, v42
  v_add_f32 v54, v35, v43
  buffer_store_dwordx4 v[48:51], v26, s[52:55], s15 offen sc1
  buffer_store_dwordx4 v[52:55], v26, s[52:55], s15 offen offset:256 sc1
L_q_nopub:
  s_cmp_eq_u32 s62, 1
  s_cbranch_scc1 L_slot2_m1
  s_add_u32 s14, s64, 1
  s_and_b32 s14, s14, 3
  s_lshl_b32 s14, s14, 15
  s_add_u32 s14, s14, s63
  s_waitcnt vmcnt(1)
  buffer_load_dwordx4 v[192:195], v28, s[48:51], s14 offen
  s_addk_i32 s14, 0x2000
  s_waitcnt vmcnt(1)
  buffer_load_dwordx4 v[196:199], v28, s[48:51], s14 offen
  s_addk_i32 s14, 0x2000
  s_waitcnt vmcnt(1)
  buffer_load_dwordx4 v[200:203], v28, s[48:51], s14 offen
  s_addk_i32 s14, 0x2000
  s_waitcnt vmcnt(1)
  buffer_load_dwordx4 v[204:207], v28, s[48:51], s14 offen
  s_addk_i32 s14, -24576
  s_waitcnt vmcnt(1)
  buffer_load_dwordx4 v[208:211], v29, s[48:51], s14 offen
  s_addk_i32 s14, 0x2000
  s_waitcnt vmcnt(1)
  buffer_load_dwordx4 v[212:215], v29, s[48:51], s14 offen
  s_addk_i32 s14, 0x2000
  s_waitcnt vmcnt(1)
  buffer_load_dwordx4 v[216:219], v29, s[48:51], s14 offen
  s_addk_i32 s14, 0x2000
  s_waitcnt vmcnt(1)
  buffer_load_dwordx4 v[220:223], v29, s[48:51], s14 offen
L_slot2_done:
  s_cmp_eq_u32 s12, 0
  s_cbranch_scc0 L_q_done
  s_lshl_b32 s10, s5, 5
  s_add_u32 s10, s10, s4
  s_lshl_b32 s10, s10, 12
  s_add_u32 s14, s10, 131072
  v_mov_b32 v10, 1
  v_mov_b32 v11, s7
  ds_write_b32 v3, v11 offset:16
  v_lshrrev_b32 v26, 1, v2
  v_lshlrev_b32 v26, 7, v26
  v_lshl_add_u32 v26, v1, 3, v26
  v_and_b32 v25, 1, v2
  v_lshl_add_u32 v26, v25, 2, v26
L_qp_5:
  buffer_load_dwordx4 v[32:35], v27, s[52:55], s14 offen sc1
  buffer_load_dwordx4 v[36:39], v27, s[52:55], s14 offen offset:1024 sc1
  buffer_load_dwordx4 v[40:43], v27, s[52:55], s14 offen offset:2048 sc1
  buffer_load_dwordx4 v[44:47], v27, s[52:55], s14 offen offset:3072 sc1
  s_waitcnt vmcnt(0)
  v_cmp_ne_u32 s[10:11], s7, v33
  v_cmp_ne_u32 vcc, s7, v35
  s_or_b64 s[10:11], s[10:11], vcc
  v_cmp_ne_u32 vcc, s7, v37
  s_or_b64 s[10:11], s[10:11], vcc
  v_cmp_ne_u32 vcc, s7, v39
  s_or_b64 s[10:11], s[10:11], vcc
  v_cmp_ne_u32 vcc, s7, v41
  s_or_b64 s[10:11], s[10:11], vcc
  v_cmp_ne_u32 vcc, s7, v43
  s_or_b64 s[10:11], s[10:11], vcc
  v_cmp_ne_u32 vcc, s7, v45
  s_or_b64 s[10:11], s[10:11], vcc
  v_cmp_ne_u32 vcc, s7, v47
  s_or_b64 s[10:11], s[10:11], vcc
  s_cbranch_scc0 L_qpd_6
  s_sleep 24
  s_add_u32 s8, s8, 1
  s_cmp_lt_u32 s8, 262144
  s_cbranch_scc1 L_qp_5
L_qpd_6:
  v_add_f32 v32, v32, v36
  v_add_f32 v40, v40, v44
  v_add_f32 v34, v34, v38
  v_add_f32 v42, v42, v46
  v_add_f32 v32, v32, v40
  v_add_f32 v34, v34, v42
  v_cvt_pk_bf16_f32 v32, v32, v34
  ds_write_b32 v26, v32 offset:256
  s_waitcnt lgkmcnt(0)
  ds_write_b32 v3, v10 offset:0
L_q_done:
  s_setprio 0
  s_branch L_helper2
L_stream_late:
  v_mov_b32 v2, 0
  s_mul_i32 s10, s9, 32768
  s_add_u32 m0, s10, 17408
  s_barrier
L_lw_7:
  ds_read_b32 v40, v2 offset:12
  s_waitcnt lgkmcnt(0)
  v_readfirstlane_b32 s10, v40
  s_cmp_ge_u32 s10, 4
  s_cbranch_scc1 L_lwd_8
  s_sleep 1
  s_add_u32 s8, s8, 1
  s_cmp_lt_u32 s8, 262144
  s_cbranch_scc1 L_lw_7
L_lwd_8:
  buffer_load_dwordx4 v[48:51], v1, s[44:47], s14 offen nt
  s_addk_i32 s14, 0x1000
  buffer_load_dwordx4 v[52:55], v1, s[44:47], s14 offen nt
  s_addk_i32 s14, 0x1000
  buffer_load_dwordx4 v[56:59], v1, s[44:47], s14 offen nt
  s_addk_i32 s14, 0x1000
  buffer_load_dwordx4 v[60:63], v1, s[44:47], s14 offen nt
  s_addk_i32 s14, 0x1000
  buffer_load_dwordx4 v[64:67], v1, s[44:47], s14 offen nt
  s_addk_i32 s14, 0x1000
  buffer_load_dwordx4 v[68:71], v1, s[44:47], s14 offen nt
  s_addk_i32 s14, 0x1000
  buffer_load_dwordx4 v[72:75], v1, s[44:47], s14 offen nt
  s_addk_i32 s14, 0x1000
  buffer_load_dwordx4 v[76:79], v1, s[44:47], s14 offen nt
  s_addk_i32 s14, 0x1000
  s_and_b32 s10, s2, 31
  s_lshl_b32 s10, s10, 7
  s_lshl_b32 s11, s4, 17
  s_add_u32 s11, s11, s10
  s_add_u32 s12, s10, 0x200000
  s_cmp_eq_u32 s9, 0
  s_cbranch_scc0 L_twb
  s_load_dword s26, s[24:25], s11
  s_load_dword s27, s[20:21], s15
  s_load_dword s26, s[36:37], s12
  s_load_dword s27, s[36:37], s10
  s_load_dword s26, s[28:29], s10
  s_load_dword s27, s[30:31], s10
  s_load_dword s26, s[32:33], s10
  s_load_dword s27, s[38:39], s10
L_twb:
  s_waitcnt vmcnt(7)
  buffer_load_dwordx4 v[80:83], v1, s[44:47], s14 offen nt
  s_addk_i32 s14, 0x1000
  s_waitcnt vmcnt(7)
  buffer_load_dwordx4 v[84:87], v1, s[44:47], s14 offen nt
  s_addk_i32 s14, 0x1000
  s_waitcnt vmcnt(7)
  buffer_load_dwordx4 v[88:91], v1, s[44:47], s14 offen nt
  s_addk_i32 s14, 0x1000
  s_waitcnt vmcnt(7)
  buffer_load_dwordx4 v[92:95], v1, s[44:47], s14 offen nt
  s_addk_i32 s14, 0x1000
  s_waitcnt vmcnt(7)
  buffer_load_dwordx4 v[96:99], v1, s[44:47], s14 offen nt
  s_addk_i32 s14, 0x1000
  s_waitcnt vmcnt(7)
  buffer_load_dwordx4 v[100:103], v1, s[44:47], s14 offen nt
  s_addk_i32 s14, 0x1000
  s_waitcnt vmcnt(7)
  buffer_load_dwordx4 v[104:107], v1, s[44:47], s14 offen nt
  s_addk_i32 s14, 0x1000
  s_waitcnt vmcnt(7)
  buffer_load_dwordx4 v[108:111], v1, s[44:47], s14 offen nt
  s_addk_i32 s14, 0x1000
  s_waitcnt vmcnt(7)
  buffer_load_dwordx4 v[112:115], v1, s[44:47], s14 offen nt
  s_addk_i32 s14, 0x1000
  s_waitcnt vmcnt(7)
  buffer_load_dwordx4 v[116:119], v1, s[44:47], s14 offen nt
  s_addk_i32 s14, 0x1000
  s_waitcnt vmcnt(7)
  buffer_load_dwordx4 v[120:123], v1, s[44:47], s14 offen nt
  s_addk_i32 s14, 0x1000
  s_waitcnt vmcnt(7)
  buffer_load_dwordx4 v[124:127], v1, s[44:47], s14 offen nt
  s_addk_i32 s14, 0x1000
  s_waitcnt vmcnt(7)
  buffer_load_dwordx4 v[128:131], v1, s[44:47], s14 offen nt
  s_addk_i32 s14, 0x1000
  s_waitcnt vmcnt(7)
  buffer_load_dwordx4 v[132:135], v1, s[44:47], s14 offen nt
  s_addk_i32 s14, 0x1000
  s_waitcnt vmcnt(7)
  buffer_load_dwordx4 v[136:139], v1, s[44:47], s14 offen nt
  s_addk_i32 s14, 0x1000
  s_waitcnt vmcnt(7)
  buffer_load_dwordx4 v[140:143], v1, s[44:47], s14 offen nt
  s_addk_i32 s14, 0x1000
  s_waitcnt vmcnt(7)
  buffer_load_dwordx4 v[144:147], v1, s[44:47], s14 offen nt
  s_addk_i32 s14, 0x1000
  s_waitcnt vmcnt(7)
  buffer_load_dwordx4 v[148:151], v1, s[44:47], s14 offen nt
  s_addk_i32 s14, 0x1000
  s_waitcnt vmcnt(7)
  buffer_load_dwordx4 v[152:155], v1, s[44:47], s14 offen nt
  s_addk_i32 s14, 0x1000
  s_waitcnt vmcnt(7)
  buffer_load_dwordx4 v[156:159], v1, s[44:47], s14 offen nt
  s_addk_i32 s14, 0x1000
  s_waitcnt vmcnt(7)
  buffer_load_dwordx4 v[160:163], v1, s[44:47], s14 offen nt
  s_addk_i32 s14, 0x1000
  s_waitcnt vmcnt(7)
  buffer_load_dwordx4 v[164:167], v1, s[44:47], s14 offen nt
  s_addk_i32 s14, 0x1000
  s_waitcnt vmcnt(7)
  buffer_load_dwordx4 v[168:171], v1, s[44:47], s14 offen nt
  s_addk_i32 s14, 0x1000
  s_waitcnt vmcnt(7)
  buffer_load_dwordx4 v[172:175], v1, s[44:47], s14 offen nt
  s_addk_i32 s14, 0x1000
  s_waitcnt vmcnt(7)
  buffer_load_dwordx4 v[176:179], v1, s[44:47], s14 offen nt
  s_addk_i32 s14, 0x1000
  s_waitcnt vmcnt(7)
  buffer_load_dwordx4 v[180:183], v1, s[44:47], s14 offen nt
  s_addk_i32 s14, 0x1000
  s_waitcnt vmcnt(7)
  buffer_load_dwordx4 v[184:187], v1, s[44:47], s14 offen nt
  s_addk_i32 s14, 0x1000
  s_waitcnt vmcnt(7)
  buffer_load_dwordx4 v[188:191], v1, s[44:47], s14 offen nt
  s_addk_i32 s14, 0x1000
  s_waitcnt vmcnt(7)
  buffer_load_dwordx4 v[192:195], v1, s[44:47], s14 offen nt
  s_addk_i32 s14, 0x1000
  s_waitcnt vmcnt(7)
  buffer_load_dwordx4 v[196:199], v1, s[44:47], s14 offen nt
  s_addk_i32 s14, 0x1000
  s_waitcnt vmcnt(7)
  buffer_load_dwordx4 v[200:203], v1, s[44:47], s14 offen nt
  s_addk_i32 s14, 0x1000
  s_waitcnt vmcnt(7)
  buffer_load_dwordx4 v[204:207], v1, s[44:47], s14 offen nt
  s_addk_i32 s14, 0x1000
  s_waitcnt vmcnt(7)
  buffer_load_dwordx4 v[208:211], v1, s[44:47], s14 offen nt
  s_addk_i32 s14, 0x1000
  s_waitcnt vmcnt(7)
  buffer_load_dwordx4 v[212:215], v1, s[44:47], s14 offen nt
  s_addk_i32 s14, 0x1000
  s_waitcnt vmcnt(7)
  buffer_load_dwordx4 v[216:219], v1, s[44:47], s14 offen nt
  s_addk_i32 s14, 0x1000
  s_waitcnt vmcnt(7)
  buffer_load_dwordx4 v[220:223], v1, s[44:47], s14 offen nt
  s_addk_i32 s14, 0x1000
  s_waitcnt vmcnt(7)
  buffer_load_dwordx4 v[224:227], v1, s[44:47], s14 offen nt
  s_addk_i32 s14, 0x1000
  s_waitcnt vmcnt(7)
  buffer_load_dwordx4 v[228:231], v1, s[44:47], s14 offen nt
  s_addk_i32 s14, 0x1000
  s_waitcnt vmcnt(7)
  buffer_load_dwordx4 v[232:235], v1, s[44:47], s14 offen nt
  s_addk_i32 s14, 0x1000
  s_waitcnt vmcnt(7)
  buffer_load_dwordx4 v[236:239], v1, s[44:47], s14 offen nt
  s_addk_i32 s14, 0x1000
  s_waitcnt vmcnt(7)
  buffer_load_dwordx4 v[240:243], v1, s[44:47], s14 offen nt
  s_addk_i32 s14, 0x1000
  s_waitcnt vmcnt(7)
  buffer_load_dwordx4 v[244:247], v1, s[44:47], s14 offen nt
  s_addk_i32 s14, 0x1000
  s_waitcnt vmcnt(7)
  buffer_load_dwordx4 v[248:251], v1, s[44:47], s14 offen nt
  s_addk_i32 s14, 0x1000
  s_waitcnt vmcnt(7)
  buffer_load_dwordx4 v[252:255], v1, s[44:47], s14 offen nt
  s_addk_i32 s14, 0x1000
  s_waitcnt vmcnt(7)
  buffer_load_dwordx4 v1, s[44:47], s14 offen nt lds
  s_add_u32 m0, m0, 0x400
  s_addk_i32 s14, 0x1000
  s_waitcnt vmcnt(7)
  buffer_load_dwordx4 v1, s[44:47], s14 offen nt lds
  s_add_u32 m0, m0, 0x400
  s_addk_i32 s14, 0x1000
  s_waitcnt vmcnt(7)
  buffer_load_dwordx4 v1, s[44:47], s14 offen nt lds
  s_add_u32 m0, m0, 0x400
  s_addk_i32 s14, 0x1000
  s_waitcnt vmcnt(7)
  buffer_load_dwordx4 v1, s[44:47], s14 offen nt lds
  s_add_u32 m0, m0, 0x400
  s_addk_i32 s14, 0x1000
  s_waitcnt vmcnt(7)
  buffer_load_dwordx4 v1, s[44:47], s14 offen nt lds
  s_add_u32 m0, m0, 0x400
  s_addk_i32 s14, 0x1000
  s_waitcnt vmcnt(7)
  buffer_load_dwordx4 v1, s[44:47], s14 offen nt lds
  s_add_u32 m0, m0, 0x400
  s_addk_i32 s14, 0x1000
  s_waitcnt vmcnt(7)
  buffer_load_dwordx4 v1, s[44:47], s14 offen nt lds
  s_add_u32 m0, m0, 0x400
  s_addk_i32 s14, 0x1000
  s_waitcnt vmcnt(7)
  buffer_load_dwordx4 v1, s[44:47], s14 offen nt lds
  s_add_u32 m0, m0, 0x400
  s_addk_i32 s14, 0x1000
  s_waitcnt vmcnt(7)
  buffer_load_dwordx4 v1, s[44:47], s14 offen nt lds
  s_add_u32 m0, m0, 0x400
  s_addk_i32 s14, 0x1000
  s_waitcnt vmcnt(7)
  buffer_load_dwordx4 v1, s[44:47], s14 offen nt lds
  s_add_u32 m0, m0, 0x400
  s_addk_i32 s14, 0x1000
  s_waitcnt vmcnt(7)
  buffer_load_dwordx4 v1, s[44:47], s14 offen nt lds
  s_add_u32 m0, m0, 0x400
  s_addk_i32 s14, 0x1000
  s_waitcnt vmcnt(7)
  buffer_load_dwordx4 v1, s[44:47], s14 offen nt lds
  s_add_u32 m0, m0, 0x400
  s_addk_i32 s14, 0x1000
  s_waitcnt vmcnt(7)
  buffer_load_dwordx4 v1, s[44:47], s14 offen nt lds
  s_add_u32 m0, m0, 0x400
  s_addk_i32 s14, 0x1000
  s_waitcnt vmcnt(7)
  buffer_load_dwordx4 v1, s[44:47], s14 offen nt lds
  s_add_u32 m0, m0, 0x400
  s_addk_i32 s14, 0x1000
  s_waitcnt vmcnt(7)
  buffer_load_dwordx4 v1, s[44:47], s14 offen nt lds
  s_add_u32 m0, m0, 0x400
  s_addk_i32 s14, 0x1000
  s_waitcnt vmcnt(7)
  buffer_load_dwordx4 v1, s[44:47], s14 offen nt lds
  s_add_u32 m0, m0, 0x400
  s_addk_i32 s14, 0x1000
  s_waitcnt vmcnt(7)
  buffer_load_dwordx4 v1, s[44:47], s14 offen nt lds
  s_add_u32 m0, m0, 0x400
  s_addk_i32 s14, 0x1000
  s_waitcnt vmcnt(7)
  buffer_load_dwordx4 v1, s[44:47], s14 offen nt lds
  s_add_u32 m0, m0, 0x400
  s_addk_i32 s14, 0x1000
  s_waitcnt vmcnt(7)
  buffer_load_dwordx4 v1, s[44:47], s14 offen nt lds
  s_add_u32 m0, m0, 0x400
  s_addk_i32 s14, 0x1000
  s_waitcnt vmcnt(7)
  buffer_load_dwordx4 v1, s[44:47], s14 offen nt lds
  s_add_u32 m0, m0, 0x400
  s_addk_i32 s14, 0x1000
  s_waitcnt vmcnt(7)
  buffer_load_dwordx4 v1, s[44:47], s14 offen nt lds
  s_add_u32 m0, m0, 0x400
  s_addk_i32 s14, 0x1000
  s_waitcnt vmcnt(7)
  buffer_load_dwordx4 v1, s[44:47], s14 offen nt lds
  s_add_u32 m0, m0, 0x400
  s_addk_i32 s14, 0x1000
  s_waitcnt vmcnt(7)
  buffer_load_dwordx4 v1, s[44:47], s14 offen nt lds
  s_add_u32 m0, m0, 0x400
  s_addk_i32 s14, 0x1000
  s_waitcnt vmcnt(7)
  buffer_load_dwordx4 v1, s[44:47], s14 offen nt lds
  s_add_u32 m0, m0, 0x400
  s_addk_i32 s14, 0x1000
  s_waitcnt vmcnt(7)
  buffer_load_dwordx4 v1, s[44:47], s14 offen nt lds
  s_add_u32 m0, m0, 0x400
  s_addk_i32 s14, 0x1000
  s_waitcnt vmcnt(7)
  buffer_load_dwordx4 v1, s[44:47], s14 offen nt lds
  s_add_u32 m0, m0, 0x400
  s_addk_i32 s14, 0x1000
  s_waitcnt vmcnt(7)
  buffer_load_dwordx4 v1, s[44:47], s14 offen nt lds
  s_add_u32 m0, m0, 0x400
  s_addk_i32 s14, 0x1000
  s_waitcnt vmcnt(7)
  buffer_load_dwordx4 v1, s[44:47], s14 offen nt lds
  s_add_u32 m0, m0, 0x400
  s_addk_i32 s14, 0x1000
  s_waitcnt vmcnt(7)
  buffer_load_dwordx4 v1, s[44:47], s14 offen nt lds
  s_add_u32 m0, m0, 0x400
  s_addk_i32 s14, 0x1000
  s_waitcnt vmcnt(7)
  buffer_load_dwordx4 v1, s[44:47], s14 offen nt lds
  s_add_u32 m0, m0, 0x400
  s_addk_i32 s14, 0x1000
  s_waitcnt vmcnt(7)
  buffer_load_dwordx4 v1, s[44:47], s14 offen nt lds
  s_add_u32 m0, m0, 0x400
  s_addk_i32 s14, 0x1000
  s_waitcnt vmcnt(7)
  buffer_load_dwordx4 v1, s[44:47], s14 offen nt lds
  s_addk_i32 s14, 0x1000
  s_waitcnt vmcnt(5)
  s_branch L_filled
L_mod2_loads:
  buffer_load_dword v64, v9, s[48:51], s10 offen
  s_addk_i32 s10, 6144
  buffer_load_dword v65, v9, s[48:51], s10 offen
  s_addk_i32 s10, 6144
  buffer_load_dword v66, v9, s[48:51], s10 offen
  s_addk_i32 s10, 6144
  buffer_load_dword v67, v9, s[48:51], s10 offen
  s_addk_i32 s10, 6144
  buffer_load_dword v68, v9, s[48:51], s10 offen
  s_addk_i32 s10, 6144
  buffer_load_dword v69, v9, s[48:51], s10 offen
  s_addk_i32 s10, 6144
  s_waitcnt vmcnt(5)
  buffer_load_dword v70, v9, s[48:51], s10 offen
  s_addk_i32 s10, 6144
  s_waitcnt vmcnt(5)
  buffer_load_dword v71, v9, s[48:51], s10 offen
  s_add_u32 s10, s10, 153600
  s_waitcnt vmcnt(5)
  buffer_load_dword v72, v9, s[48:51], s10 offen
  s_addk_i32 s10, 6144
  s_waitcnt vmcnt(5)
  buffer_load_dword v73, v9, s[48:51], s10 offen
  s_addk_i32 s10, 6144
  s_waitcnt vmcnt(5)
  buffer_load_dword v74, v9, s[48:51], s10 offen
  s_addk_i32 s10, 6144
  s_waitcnt vmcnt(5)
  buffer_load_dword v75, v9, s[48:51], s10 offen
  s_addk_i32 s10, 6144
  s_waitcnt vmcnt(5)
  buffer_load_dword v76, v9, s[48:51], s10 offen
  s_addk_i32 s10, 6144
  s_waitcnt vmcnt(5)
  buffer_load_dword v77, v9, s[48:51], s10 offen
  s_addk_i32 s10, 6144
  s_waitcnt vmcnt(5)
  buffer_load_dword v78, v9, s[48:51], s10 offen
  s_addk_i32 s10, 6144
  s_waitcnt vmcnt(5)
  buffer_load_dword v79, v9, s[48:51], s10 offen
  s_add_u32 s10, s10, 153600
  s_waitcnt vmcnt(5)
  buffer_load_dword v80, v9, s[48:51], s10 offen
  s_addk_i32 s10, 6144
  s_waitcnt vmcnt(5)
  buffer_load_dword v81, v9, s[48:51], s10 offen
  s_addk_i32 s10, 6144
  s_waitcnt vmcnt(5)
  buffer_load_dword v82, v9, s[48:51], s10 offen
  s_addk_i32 s10, 6144
  s_waitcnt vmcnt(5)
  buffer_load_dword v83, v9, s[48:51], s10 offen
  s_addk_i32 s10, 6144
  s_waitcnt vmcnt(5)
  buffer_load_dword v84, v9, s[48:51], s10 offen
  s_addk_i32 s10, 6144
  s_waitcnt vmcnt(5)
  buffer_load_dword v85, v9, s[48:51], s10 offen
  s_addk_i32 s10, 6144
  s_waitcnt vmcnt(5)
  buffer_load_dword v86, v9, s[48:51], s10 offen
  s_addk_i32 s10, 6144
  s_waitcnt vmcnt(5)
  buffer_load_dword v87, v9, s[48:51], s10 offen
  s_add_u32 s10, s10, 153600
  s_waitcnt vmcnt(5)
  buffer_load_dword v88, v9, s[48:51], s10 offen
  s_addk_i32 s10, 6144
  s_waitcnt vmcnt(5)
  buffer_load_dword v89, v9, s[48:51], s10 offen
  s_addk_i32 s10, 6144
  s_waitcnt vmcnt(5)
  buffer_load_dword v90, v9, s[48:51], s10 offen
  s_addk_i32 s10, 6144
  s_waitcnt vmcnt(5)
  buffer_load_dword v91, v9, s[48:51], s10 offen
  s_addk_i32 s10, 6144
  s_waitcnt vmcnt(5)
  buffer_load_dword v92, v9, s[48:51], s10 offen
  s_addk_i32 s10, 6144
  s_waitcnt vmcnt(5)
  buffer_load_dword v93, v9, s[48:51], s10 offen
  s_addk_i32 s10, 6144
  s_waitcnt vmcnt(5)
  buffer_load_dword v94, v9, s[48:51], s10 offen
  s_addk_i32 s10, 6144
  s_waitcnt vmcnt(5)
  buffer_load_dword v95, v9, s[48:51], s10 offen
  s_waitcnt vmcnt(0)
  s_branch L_mod_loaded
L_mod2_pub:
  buffer_store_dwordx2 v[10:11], v9, s[52:55], s10 offen sc1
  s_branch L_mod_done
L_slot2_m1:
  s_add_u32 s14, s64, 0
  s_and_b32 s14, s14, 3
  s_lshl_b32 s14, s14, 15
  s_add_u32 s14, s14, s63
  s_waitcnt vmcnt(1)
  buffer_load_dwordx4 v[160:163], v28, s[48:51], s14 offen
  s_addk_i32 s14, 0x2000
  s_waitcnt vmcnt(1)
  buffer_load_dwordx4 v[164:167], v28, s[48:51], s14 offen
  s_addk_i32 s14, 0x2000
  s_waitcnt vmcnt(1)
  buffer_load_dwordx4 v[168:171], v28, s[48:51], s14 offen
  s_addk_i32 s14, 0x2000
  s_waitcnt vmcnt(1)
  buffer_load_dwordx4 v[172:175], v28, s[48:51], s14 offen
  s_addk_i32 s14, -24576
  s_waitcnt vmcnt(1)
  buffer_load_dwordx4 v[176:179], v29, s[48:51], s14 offen
  s_addk_i32 s14, 0x2000
  s_waitcnt vmcnt(1)
  buffer_load_dwordx4 v[180:183], v29, s[48:51], s14 offen
  s_addk_i32 s14, 0x2000
  s_waitcnt vmcnt(1)
  buffer_load_dwordx4 v[184:187], v29, s[48:51], s14 offen
  s_addk_i32 s14, 0x2000
  s_waitcnt vmcnt(1)
  buffer_load_dwordx4 v[188:191], v29, s[48:51], s14 offen
  s_branch L_slot2_done
L_helper2:
  s_cmp_eq_u32 s62, 1
  s_cbranch_scc0 L_slot3_done
  s_add_u32 s14, s64, 1
  s_and_b32 s14, s14, 3
  s_lshl_b32 s14, s14, 15
  s_add_u32 s14, s14, s63
  s_waitcnt vmcnt(1)
  buffer_load_dwordx4 v[192:195], v28, s[48:51], s14 offen
  s_addk_i32 s14, 0x2000
  s_waitcnt vmcnt(1)
  buffer_load_dwordx4 v[196:199], v28, s[48:51], s14 offen
  s_addk_i32 s14, 0x2000
  s_waitcnt vmcnt(1)
  buffer_load_dwordx4 v[200:203], v28, s[48:51], s14 offen
  s_addk_i32 s14, 0x2000
  s_waitcnt vmcnt(1)
  buffer_load_dwordx4 v[204:207], v28, s[48:51], s14 offen
  s_addk_i32 s14, -24576
  s_waitcnt vmcnt(1)
  buffer_load_dwordx4 v[208:211], v29, s[48:51], s14 offen
  s_addk_i32 s14, 0x2000
  s_waitcnt vmcnt(1)
  buffer_load_dwordx4 v[212:215], v29, s[48:51], s14 offen
  s_addk_i32 s14, 0x2000
  s_waitcnt vmcnt(1)
  buffer_load_dwordx4 v[216:219], v29, s[48:51], s14 offen
  s_addk_i32 s14, 0x2000
  s_waitcnt vmcnt(1)
  buffer_load_dwordx4 v[220:223], v29, s[48:51], s14 offen
L_slot3_done:
  s_lshr_b32 s12, s2, 6
  s_cmp_eq_u32 s12, 2
  s_cbranch_scc0 L_after_mod2
  s_and_b32 s10, s2, 7
  s_bfe_u32 s11, s2, 0x30003
  s_lshl_b32 s10, s10, 3
  s_add_u32 s100, s10, s11
  s_add_u32 s100, s100, 32
  s_branch L_mod
L_after_mod2:
  s_mov_b32 s48, s24
  s_mov_b32 s49, s25
  s_mov_b32 s50, 4194304
  s_mov_b32 s51, 0x20000
  v_lshlrev_b32 v28, 11, v2
  v_lshl_add_u32 v28, v1, 4, v28
  s_lshl_b32 s10, s6, 10
  s_xor_b32 s11, s10, 0x400
  v_add_u32 v29, s11, v28
  v_add_u32 v28, s10, v28
  s_add_u32 s14, s64, 2
  s_and_b32 s14, s14, 3
  s_lshl_b32 s14, s14, 15
  s_add_u32 s14, s14, s63
  s_waitcnt vmcnt(1)
  buffer_load_dwordx4 v[224:227], v28, s[48:51], s14 offen
  s_addk_i32 s14, 0x2000
  s_waitcnt vmcnt(1)
  buffer_load_dwordx4 v[228:231], v28, s[48:51], s14 offen
  s_addk_i32 s14, 0x2000
  s_waitcnt vmcnt(1)
  buffer_load_dwordx4 v[232:235], v28, s[48:51], s14 offen
  s_addk_i32 s14, 0x2000
  s_waitcnt vmcnt(1)
  buffer_load_dwordx4 v[236:239], v28, s[48:51], s14 offen
  s_addk_i32 s14, -24576
  s_waitcnt vmcnt(1)
  buffer_load_dwordx4 v[240:243], v29, s[48:51], s14 offen
  s_addk_i32 s14, 0x2000
  s_waitcnt vmcnt(1)
  buffer_load_dwordx4 v[244:247], v29, s[48:51], s14 offen
  s_addk_i32 s14, 0x2000
  s_waitcnt vmcnt(1)
  buffer_load_dwordx4 v[248:251], v29, s[48:51], s14 offen
  s_addk_i32 s14, 0x2000
  s_waitcnt vmcnt(1)
  buffer_load_dwordx4 v[252:255], v29, s[48:51], s14 offen
  s_add_u32 s14, s64, 3
  s_and_b32 s14, s14, 3
  s_lshl_b32 s14, s14, 15
  s_add_u32 s14, s14, s63
  s_waitcnt vmcnt(1)
  buffer_load_dwordx4 v[32:35], v28, s[48:51], s14 offen
  s_addk_i32 s14, 0x2000
  s_waitcnt vmcnt(1)
  buffer_load_dwordx4 v[36:39], v28, s[48:51], s14 offen
  s_addk_i32 s14, 0x2000
  s_waitcnt vmcnt(1)
  buffer_load_dwordx4 v[40:43], v28, s[48:51], s14 offen
  s_addk_i32 s14, 0x2000
  s_waitcnt vmcnt(1)
  buffer_load_dwordx4 v[44:47], v28, s[48:51], s14 offen
  s_addk_i32 s14, -24576
  s_waitcnt vmcnt(1)
  buffer_load_dwordx4 v[48:51], v29, s[48:51], s14 offen
  s_addk_i32 s14, 0x2000
  s_waitcnt vmcnt(1)
  buffer_load_dwordx4 v[52:55], v29, s[48:51], s14 offen
  s_addk_i32 s14, 0x2000
  s_waitcnt vmcnt(1)
  buffer_load_dwordx4 v[56:59], v29, s[48:51], s14 offen
  s_addk_i32 s14, 0x2000
  s_waitcnt vmcnt(1)
  buffer_load_dwordx4 v[60:63], v29, s[48:51], s14 offen
  s_waitcnt vmcnt(0)
  v_perm_b32 v128, v164, v160, s68
  v_perm_b32 v132, v164, v160, s69
  v_perm_b32 v129, v172, v168, s68
  v_perm_b32 v133, v172, v168, s69
  v_perm_b32 v130, v180, v176, s68
  v_perm_b32 v134, v180, v176, s69
  v_perm_b32 v131, v188, v184, s68
  v_perm_b32 v135, v188, v184, s69
  v_perm_b32 v136, v165, v161, s68
  v_perm_b32 v140, v165, v161, s69
  v_perm_b32 v137, v173, v169, s68
  v_perm_b32 v141, v173, v169, s69
  v_perm_b32 v138, v181, v177, s68
  v_perm_b32 v142, v181, v177, s69
  v_perm_b32 v139, v189, v185, s68
  v_perm_b32 v143, v189, v185, s69
  v_perm_b32 v144, v166, v162, s68
  v_perm_b32 v148, v166, v162, s69
  v_perm_b32 v145, v174, v170, s68
  v_perm_b32 v149, v174, v170, s69
  v_perm_b32 v146, v182, v178, s68
  v_perm_b32 v150, v182, v178, s69
  v_perm_b32 v147, v190, v186, s68
  v_perm_b32 v151, v190, v186, s69
  v_perm_b32 v152, v167, v163, s68
  v_perm_b32 v156, v167, v163, s69
  v_perm_b32 v153, v175, v171, s68
  v_perm_b32 v157, v175, v171, s69
  v_perm_b32 v154, v183, v179, s68
  v_perm_b32 v158, v183, v179, s69
  v_perm_b32 v155, v191, v187, s68
  v_perm_b32 v159, v191, v187, s69
  v_perm_b32 v160, v196, v192, s68
  v_perm_b32 v164, v196, v192, s69
  v_perm_b32 v161, v204, v200, s68
  v_perm_b32 v165, v204, v200, s69
  v_perm_b32 v162, v212, v208, s68
  v_perm_b32 v166, v212, v208, s69
  v_perm_b32 v163, v220, v216, s68
  v_perm_b32 v167, v220, v216, s69
  v_perm_b32 v168, v197, v193, s68
  v_perm_b32 v172, v197, v193, s69
  v_perm_b32 v169, v205, v201, s68
  v_perm_b32 v173, v205, v201, s69
  v_perm_b32 v170, v213, v209, s68
  v_perm_b32 v174, v213, v209, s69
  v_perm_b32 v171, v221, v217, s68
  v_perm_b32 v175, v221, v217, s69
  v_perm_b32 v176, v198, v194, s68
  v_perm_b32 v180, v198, v194, s69
  v_perm_b32 v177, v206, v202, s68
  v_perm_b32 v181, v206, v202, s69
  v_perm_b32 v178, v214, v210, s68
  v_perm_b32 v182, v214, v210, s69
  v_perm_b32 v179, v222, v218, s68
  v_perm_b32 v183, v222, v218, s69
  v_perm_b32 v184, v199, v195, s68
  v_perm_b32 v188, v199, v195, s69
  v_perm_b32 v185, v207, v203, s68
  v_perm_b32 v189, v207, v203, s69
  v_perm_b32 v186, v215, v211, s68
  v_perm_b32 v190, v215, v211, s69
  v_perm_b32 v187, v223, v219, s68
  v_perm_b32 v191, v223, v219, s69
  v_perm_b32 v192, v228, v224, s68
  v_perm_b32 v196, v228, v224, s69
  v_perm_b32 v193, v236, v232, s68
  v_perm_b32 v197, v236, v232, s69
  v_perm_b32 v194, v244, v240, s68
  v_perm_b32 v198, v244, v240, s69
  v_perm_b32 v195, v252, v248, s68
  v_perm_b32 v199, v252, v248, s69
  v_perm_b32 v200, v229, v225, s68
  v_perm_b32 v204, v229, v225, s69
  v_perm_b32 v201, v237, v233, s68
  v_perm_b32 v205, v237, v233, s69
  v_perm_b32 v202, v245, v241, s68
  v_perm_b32 v206, v245, v241, s69
  v_perm_b32 v203, v253, v249, s68
  v_perm_b32 v207, v253, v249, s69
  v_perm_b32 v208, v230, v226, s68
  v_perm_b32 v212, v230, v226, s69
  v_perm_b32 v209, v238, v234, s68
  v_perm_b32 v213, v238, v234, s69
  v_perm_b32 v210, v246, v242, s68
  v_perm_b32 v214, v246, v242, s69
  v_perm_b32 v211, v254, v250, s68
  v_perm_b32 v215, v254, v250, s69
  v_perm_b32 v216, v231, v227, s68
  v_perm_b32 v220, v231, v227, s69
  v_perm_b32 v217, v239, v235, s68
  v_perm_b32 v221, v239, v235, s69
  v_perm_b32 v218, v247, v243, s68
  v_perm_b32 v222, v247, v243, s69
  v_perm_b32 v219, v255, v251, s68
  v_perm_b32 v223, v255, v251, s69
  v_perm_b32 v224, v36, v32, s68
  v_perm_b32 v228, v36, v32, s69
  v_perm_b32 v225, v44, v40, s68
  v_perm_b32 v229, v44, v40, s69
  v_perm_b32 v226, v52, v48, s68
  v_perm_b32 v230, v52, v48, s69
  v_perm_b32 v227, v60, v56, s68
  v_perm_b32 v231, v60, v56, s69
  v_perm_b32 v232, v37, v33, s68
  v_perm_b32 v236, v37, v33, s69
  v_perm_b32 v233, v45, v41, s68
  v_perm_b32 v237, v45, v41, s69
  v_perm_b32 v234, v53, v49, s68
  v_perm_b32 v238, v53, v49, s69
  v_perm_b32 v235, v61, v57, s68
  v_perm_b32 v239, v61, v57, s69
  v_perm_b32 v240, v38, v34, s68
  v_perm_b32 v244, v38, v34, s69
  v_perm_b32 v241, v46, v42, s68
  v_perm_b32 v245, v46, v42, s69
  v_perm_b32 v242, v54, v50, s68
  v_perm_b32 v246, v54, v50, s69
  v_perm_b32 v243, v62, v58, s68
  v_perm_b32 v247, v62, v58, s69
  v_perm_b32 v248, v39, v35, s68
  v_perm_b32 v252, v39, v35, s69
  v_perm_b32 v249, v47, v43, s68
  v_perm_b32 v253, v47, v43, s69
  v_perm_b32 v250, v55, v51, s68
  v_perm_b32 v254, v55, v51, s69
  v_perm_b32 v251, v63, v59, s68
  v_perm_b32 v255, v63, v59, s69
  s_mov_b32 s98, 0
  s_cmp_ge_u32 s2, 128
  s_cbranch_scc1 L_setup_done
  s_and_b32 s10, s2, 7
  s_lshl_b32 s10, s10, 2
  s_bfe_u32 s11, s2, 0x20003
  s_add_u32 s99, s10, s11
  s_cmp_ge_u32 s2, 96
  s_cbranch_scc1 L_setup_down
  s_cmp_ge_u32 s2, 88
  s_cbranch_scc1 L_setup_done
  s_and_b32 s10, s2, 7
  s_mul_i32 s10, s10, 11
  s_lshr_b32 s11, s2, 3
  s_add_u32 s99, s10, s11
  s_cmp_ge_u32 s99, 87
  s_cbranch_scc1 L_setup_done
  s_mov_b32 s98, 1
  s_cmp_eq_u32 s99, 86
  s_cbranch_scc1 L_gate_params
  s_mov_b32 s44, s28
  s_mov_b32 s45, s29
  s_mov_b32 s46, 1409024
  s_mov_b32 s47, 0x20000
  s_mov_b32 s48, s30
  s_mov_b32 s49, s31
  s_mov_b32 s50, 1409024
  s_mov_b32 s51, 0x20000
  v_mul_u32_u24 v8, 88064, v2
  v_and_b32 v9, 7, v0
  v_lshl_add_u32 v8, v9, 2, v8
  s_mul_i32 s10, s9, 352256
  s_lshl_b32 s11, s99, 5
  s_add_u32 s12, s10, s11
  s_mov_b32 exec_lo, 0xff00ff
  s_mov_b32 exec_hi, 0xff00ff
  s_add_u32 s14, s12, 0
  buffer_load_dword v32, v8, s[44:47], s14 offen
  s_addk_i32 s14, 22016
  buffer_load_dword v33, v8, s[44:47], s14 offen
  s_addk_i32 s14, 22016
  buffer_load_dword v34, v8, s[44:47], s14 offen
  s_addk_i32 s14, 22016
  buffer_load_dword v35, v8, s[44:47], s14 offen
  s_add_u32 s14, s12, 11008
  buffer_load_dword v36, v8, s[44:47], s14 offen
  s_addk_i32 s14, 22016
  buffer_load_dword v37, v8, s[44:47], s14 offen
  s_addk_i32 s14, 22016
  s_waitcnt vmcnt(5)
  buffer_load_dword v38, v8, s[44:47], s14 offen
  s_addk_i32 s14, 22016
  s_waitcnt vmcnt(5)
  buffer_load_dword v39, v8, s[44:47], s14 offen
  s_add_u32 s14, s12, 2752
  s_waitcnt vmcnt(5)
  buffer_load_dword v40, v8, s[44:47], s14 offen
  s_addk_i32 s14, 22016
  s_waitcnt vmcnt(5)
  buffer_load_dword v41, v8, s[44:47], s14 offen
  s_addk_i32 s14, 22016
  s_waitcnt vmcnt(5)
  buffer_load_dword v42, v8, s[44:47], s14 offen
  s_addk_i32 s14, 22016
  s_waitcnt vmcnt(5)
  buffer_load_dword v43, v8, s[44:47], s14 offen
  s_add_u32 s14, s12, 13760
  s_waitcnt vmcnt(5)
  buffer_load_dword v44, v8, s[44:47], s14 offen
  s_addk_i32 s14, 22016
  s_waitcnt vmcnt(5)
  buffer_load_dword v45, v8, s[44:47], s14 offen
  s_addk_i32 s14, 22016
  s_waitcnt vmcnt(5)
  buffer_load_dword v46, v8, s[44:47], s14 offen
  s_addk_i32 s14, 22016
  s_waitcnt vmcnt(5)
  buffer_load_dword v47, v8, s[44:47], s14 offen
  s_add_u32 s14, s12, 5504
  s_waitcnt vmcnt(5)
  buffer_load_dword v48, v8, s[44:47], s14 offen
  s_addk_i32 s14, 22016
  s_waitcnt vmcnt(5)
  buffer_load_dword v49, v8, s[44:47], s14 offen
  s_addk_i32 s14, 22016
  s_waitcnt vmcnt(5)
  buffer_load_dword v50, v8, s[44:47], s14 offen
  s_addk_i32 s14, 22016
  s_waitcnt vmcnt(5)
  buffer_load_dword v51, v8, s[44:47], s14 offen
  s_add_u32 s14, s12, 16512
  s_waitcnt vmcnt(5)
  buffer_load_dword v52, v8, s[44:47], s14 offen
  s_addk_i32 s14, 22016
  s_waitcnt vmcnt(5)
  buffer_load_dword v53, v8, s[44:47], s14 offen
  s_addk_i32 s14, 22016
  s_waitcnt vmcnt(5)
  buffer_load_dword v54, v8, s[44:47], s14 offen
  s_addk_i32 s14, 22016
  s_waitcnt vmcnt(5)
  buffer_load_dword v55, v8, s[44:47], s14 offen
  s_add_u32 s14, s12, 8256
  s_waitcnt vmcnt(5)
  buffer_load_dword v56, v8, s[44:47], s14 offen
  s_addk_i32 s14, 22016
  s_waitcnt vmcnt(5)
  buffer_load_dword v57, v8, s[44:47], s14 offen
  s_addk_i32 s14, 22016
  s_waitcnt vmcnt(5)
  buffer_load_dword v58, v8, s[44:47], s14 offen
  s_addk_i32 s14, 22016
  s_waitcnt vmcnt(5)
  buffer_load_dword v59, v8, s[44:47], s14 offen
  s_add_u32 s14, s12, 19264
  s_waitcnt vmcnt(5)
  buffer_load_dword v60, v8, s[44:47], s14 offen
  s_addk_i32 s14, 22016
  s_waitcnt vmcnt(5)
  buffer_load_dword v61, v8, s[44:47], s14 offen
  s_addk_i32 s14, 22016
  s_waitcnt vmcnt(5)
  buffer_load_dword v62, v8, s[44:47], s14 offen
  s_addk_i32 s14, 22016
  s_waitcnt vmcnt(5)
  buffer_load_dword v63, v8, s[44:47], s14 offen
  s_mov_b32 exec_lo, 0xff00ff00
  s_mov_b32 exec_hi, 0xff00ff00
  s_add_u32 s14, s12, 0
  s_waitcnt vmcnt(5)
  buffer_load_dword v32, v8, s[48:51], s14 offen
  s_addk_i32 s14, 22016
  s_waitcnt vmcnt(5)
  buffer_load_dword v33, v8, s[48:51], s14 offen
  s_addk_i32 s14, 22016
  s_waitcnt vmcnt(5)
  buffer_load_dword v34, v8, s[48:51], s14 offen
  s_addk_i32 s14, 22016
  s_waitcnt vmcnt(5)
  buffer_load_dword v35, v8, s[48:51], s14 offen
  s_add_u32 s14, s12, 11008
  s_waitcnt vmcnt(5)
  buffer_load_dword v36, v8, s[48:51], s14 offen
  s_addk_i32 s14, 22016
  s_waitcnt vmcnt(5)
  buffer_load_dword v37, v8, s[48:51], s14 offen
  s_addk_i32 s14, 22016
  s_waitcnt vmcnt(5)
  buffer_load_dword v38, v8, s[48:51], s14 offen
  s_addk_i32 s14, 22016
  s_waitcnt vmcnt(5)
  buffer_load_dword v39, v8, s[48:51], s14 offen
  s_add_u32 s14, s12, 2752
  s_waitcnt vmcnt(5)
  buffer_load_dword v40, v8, s[48:51], s14 offen
  s_addk_i32 s14, 22016
  s_waitcnt vmcnt(5)
  buffer_load_dword v41, v8, s[48:51], s14 offen
  s_addk_i32 s14, 22016
  s_waitcnt vmcnt(5)
  buffer_load_dword v42, v8, s[48:51], s14 offen
  s_addk_i32 s14, 22016
  s_waitcnt vmcnt(5)
  buffer_load_dword v43, v8, s[48:51], s14 offen
  s_add_u32 s14, s12, 13760
  s_waitcnt vmcnt(5)
  buffer_load_dword v44, v8, s[48:51], s14 offen
  s_addk_i32 s14, 22016
  s_waitcnt vmcnt(5)
  buffer_load_dword v45, v8, s[48:51], s14 offen
  s_addk_i32 s14, 22016
  s_waitcnt vmcnt(5)
  buffer_load_dword v46, v8, s[48:51], s14 offen
  s_addk_i32 s14, 22016
  s_waitcnt vmcnt(5)
  buffer_load_dword v47, v8, s[48:51], s14 offen
  s_add_u32 s14, s12, 5504
  s_waitcnt vmcnt(5)
  buffer_load_dword v48, v8, s[48:51], s14 offen
  s_addk_i32 s14, 22016
  s_waitcnt vmcnt(5)
  buffer_load_dword v49, v8, s[48:51], s14 offen
  s_addk_i32 s14, 22016
  s_waitcnt vmcnt(5)
  buffer_load_dword v50, v8, s[48:51], s14 offen
  s_addk_i32 s14, 22016
  s_waitcnt vmcnt(5)
  buffer_load_dword v51, v8, s[48:51], s14 offen
  s_add_u32 s14, s12, 16512
  s_waitcnt vmcnt(5)
  buffer_load_dword v52, v8, s[48:51], s14 offen
  s_addk_i32 s14, 22016
  s_waitcnt vmcnt(5)
  buffer_load_dword v53, v8, s[48:51], s14 offen
  s_addk_i32 s14, 22016
  s_waitcnt vmcnt(5)
  buffer_load_dword v54, v8, s[48:51], s14 offen
  s_addk_i32 s14, 22016
  s_waitcnt vmcnt(5)
  buffer_load_dword v55, v8, s[48:51], s14 offen
  s_add_u32 s14, s12, 8256
  s_waitcnt vmcnt(5)
  buffer_load_dword v56, v8, s[48:51], s14 offen
  s_addk_i32 s14, 22016
  s_waitcnt vmcnt(5)
  buffer_load_dword v57, v8, s[48:51], s14 offen
  s_addk_i32 s14, 22016
  s_waitcnt vmcnt(5)
  buffer_load_dword v58, v8, s[48:51], s14 offen
  s_addk_i32 s14, 22016
  s_waitcnt vmcnt(5)
  buffer_load_dword v59, v8, s[48:51], s14 offen
  s_add_u32 s14, s12, 19264
  s_waitcnt vmcnt(5)
  buffer_load_dword v60, v8, s[48:51], s14 offen
  s_addk_i32 s14, 22016
  s_waitcnt vmcnt(5)
  buffer_load_dword v61, v8, s[48:51], s14 offen
  s_addk_i32 s14, 22016
  s_waitcnt vmcnt(5)
  buffer_load_dword v62, v8, s[48:51], s14 offen
  s_addk_i32 s14, 22016
  s_waitcnt vmcnt(5)
  buffer_load_dword v63, v8, s[48:51], s14 offen
  s_mov_b64 exec, -1
  s_waitcnt vmcnt(0)
  v_perm_b32 v64, v33, v32, s68
  v_perm_b32 v68, v33, v32, s69
  v_perm_b32 v65, v35, v34, s68
  v_perm_b32 v69, v35, v34, s69
  v_perm_b32 v66, v37, v36, s68
  v_perm_b32 v70, v37, v36, s69
  v_perm_b32 v67, v39, v38, s68
  v_perm_b32 v71, v39, v38, s69
  v_perm_b32 v72, v41, v40, s68
  v_perm_b32 v76, v41, v40, s69
  v_perm_b32 v73, v43, v42, s68
  v_perm_b32 v77, v43, v42, s69
  v_perm_b32 v74, v45, v44, s68
  v_perm_b32 v78, v45, v44, s69
  v_perm_b32 v75, v47, v46, s68
  v_perm_b32 v79, v47, v46, s69
  v_perm_b32 v80, v49, v48, s68
  v_perm_b32 v84, v49, v48, s69
  v_perm_b32 v81, v51, v50, s68
  v_perm_b32 v85, v51, v50, s69
  v_perm_b32 v82, v53, v52, s68
  v_perm_b32 v86, v53, v52, s69
  v_perm_b32 v83, v55, v54, s68
  v_perm_b32 v87, v55, v54, s69
  v_perm_b32 v88, v57, v56, s68
  v_perm_b32 v92, v57, v56, s69
  v_perm_b32 v89, v59, v58, s68
  v_perm_b32 v93, v59, v58, s69
  v_perm_b32 v90, v61, v60, s68
  v_perm_b32 v94, v61, v60, s69
  v_perm_b32 v91, v63, v62, s68
  v_perm_b32 v95, v63, v62, s69
L_gate_params:
  v_lshlrev_b32 v8, 7, v2
  v_and_b32 v9, 3, v0
  v_lshl_add_u32 v8, v9, 5, v8
  v_bfe_u32 v9, v0, 2, 2
  v_add_u32 v8, v8, v9
  s_mov_b32 s44, s16
  s_mov_b32 s45, s17
  s_mov_b32 s46, 4096
  s_mov_b32 s47, 0x20000
  s_mul_i32 s13, s9, 1088
  v_lshlrev_b32 v8, 1, v8
  v_add_u32 v8, s13, v8
  v_lshlrev_b32 v9, 4, v0
  v_add_u32 v10, s13, v9
  s_lshl_b32 s10, s9, 10
  buffer_load_dwordx4 v[56:59], v9, s[44:47], s10 offen
  v_lshlrev_b32 v9, 5, v0
  s_mul_i32 s12, s9, 12288
  s_add_u32 s12, s12, 86016
L_gp_356:
  s_mov_b32 s14, s12
  buffer_load_dwordx4 v[32:35], v9, s[52:55], s14 offen sc1
  buffer_load_dwordx4 v[36:39], v9, s[52:55], s14 offen offset:16 sc1
  s_waitcnt vmcnt(0)
  s_addk_i32 s14, 0x800
  buffer_load_dwordx4 v[40:43], v9, s[52:55], s14 offen sc1
  buffer_load_dwordx4 v[44:47], v9, s[52:55], s14 offen offset:16 sc1
  s_waitcnt vmcnt(0)
  s_addk_i32 s14, 0x800
  buffer_load_dwordx4 v[48:51], v9, s[52:55], s14 offen sc1
  buffer_load_dwordx4 v[52:55], v9, s[52:55], s14 offen offset:16 sc1
  s_waitcnt vmcnt(0)
  v_cmp_ne_u32 s[10:11], s7, v33
  v_cmp_ne_u32 vcc, s7, v35
  s_or_b64 s[10:11], s[10:11], vcc
  v_cmp_ne_u32 vcc, s7, v37
  s_or_b64 s[10:11], s[10:11], vcc
  v_cmp_ne_u32 vcc, s7, v39
  s_or_b64 s[10:11], s[10:11], vcc
  v_cmp_ne_u32 vcc, s7, v41
  s_or_b64 s[10:11], s[10:11], vcc
  v_cmp_ne_u32 vcc, s7, v43
  s_or_b64 s[10:11], s[10:11], vcc
  v_cmp_ne_u32 vcc, s7, v45
  s_or_b64 s[10:11], s[10:11], vcc
  v_cmp_ne_u32 vcc, s7, v47
  s_or_b64 s[10:11], s[10:11], vcc
  v_cmp_ne_u32 vcc, s7, v49
  s_or_b64 s[10:11], s[10:11], vcc
  v_cmp_ne_u32 vcc, s7, v51
  s_or_b64 s[10:11], s[10:11], vcc
  v_cmp_ne_u32 vcc, s7, v53
  s_or_b64 s[10:11], s[10:11], vcc
  v_cmp_ne_u32 vcc, s7, v55
  s_or_b64 s[10:11], s[10:11], vcc
  s_cbranch_scc0 L_gpd_357
  s_sleep 32
  s_add_u32 s8, s8, 1
  s_cmp_lt_u32 s8, 262144
  s_cbranch_scc1 L_gp_356
L_gpd_357:
  v_mov_b32 v33, v34
  v_mov_b32 v34, v36
  v_mov_b32 v35, v38
  ds_write_b128 v10, v[32:35] offset:2816
  s_waitcnt lgkmcnt(0)
  ds_read_u16 v104, v8 offset:2816
  ds_read_u16 v105, v8 offset:2832
  ds_read_u16 v106, v8 offset:2848
  ds_read_u16 v107, v8 offset:2864
  ds_read_u16 v108, v8 offset:2824
  ds_read_u16 v109, v8 offset:2840
  ds_read_u16 v110, v8 offset:2856
  ds_read_u16 v111, v8 offset:2872
  s_waitcnt lgkmcnt(0)
  v_mov_b32 v41, v42
  v_mov_b32 v42, v44
  v_mov_b32 v43, v46
  ds_write_b128 v10, v[40:43] offset:2816
  s_waitcnt lgkmcnt(0)
  ds_read_u16 v120, v8 offset:2816
  ds_read_u16 v121, v8 offset:2832
  ds_read_u16 v122, v8 offset:2848
  ds_read_u16 v123, v8 offset:2864
  ds_read_u16 v124, v8 offset:2824
  ds_read_u16 v125, v8 offset:2840
  ds_read_u16 v126, v8 offset:2856
  ds_read_u16 v127, v8 offset:2872
  s_waitcnt lgkmcnt(0)
  v_mov_b32 v49, v50
  v_mov_b32 v50, v52
  v_mov_b32 v51, v54
  ds_write_b128 v10, v[48:51] offset:2816
  s_waitcnt lgkmcnt(0)
  ds_read_u16 v112, v8 offset:2816
  ds_read_u16 v113, v8 offset:2832
  ds_read_u16 v114, v8 offset:2848
  ds_read_u16 v115, v8 offset:2864
  ds_read_u16 v116, v8 offset:2824
  ds_read_u16 v117, v8 offset:2840
  ds_read_u16 v118, v8 offset:2856
  ds_read_u16 v119, v8 offset:2872
  s_waitcnt lgkmcnt(0)
  ds_write_b128 v10, v[56:59] offset:2816
  s_waitcnt lgkmcnt(0)
  ds_read_u16 v96, v8 offset:2816
  ds_read_u16 v97, v8 offset:2832
  ds_read_u16 v98, v8 offset:2848
  ds_read_u16 v99, v8 offset:2864
  ds_read_u16 v100, v8 offset:2824
  ds_read_u16 v101, v8 offset:2840
  ds_read_u16 v102, v8 offset:2856
  ds_read_u16 v103, v8 offset:2872
  s_waitcnt lgkmcnt(0)
  v_lshlrev_b32 v120, 16, v120
  v_lshlrev_b32 v112, 16, v112
  v_lshlrev_b32 v96, 16, v96
  v_add_f32 v112, 1.0, v112
  v_lshlrev_b32 v105, 16, v105
  v_lshlrev_b32 v121, 16, v121
  v_lshlrev_b32 v113, 16, v113
  v_lshlrev_b32 v97, 16, v97
  v_add_f32 v113, 1.0, v113
  v_lshlrev_b32 v122, 16, v122
  v_lshlrev_b32 v114, 16, v114
  v_lshlrev_b32 v98, 16, v98
  v_add_f32 v114, 1.0, v114
  v_lshlrev_b32 v107, 16, v107
  v_lshlrev_b32 v123, 16, v123
  v_lshlrev_b32 v115, 16, v115
  v_lshlrev_b32 v99, 16, v99
  v_add_f32 v115, 1.0, v115
  v_lshlrev_b32 v124, 16, v124
  v_lshlrev_b32 v116, 16, v116
  v_lshlrev_b32 v100, 16, v100
  v_add_f32 v116, 1.0, v116
  v_lshlrev_b32 v109, 16, v109
  v_lshlrev_b32 v125, 16, v125
  v_lshlrev_b32 v117, 16, v117
  v_lshlrev_b32 v101, 16, v101
  v_add_f32 v117, 1.0, v117
  v_lshlrev_b32 v126, 16, v126
  v_lshlrev_b32 v118, 16, v118
  v_lshlrev_b32 v102, 16, v102
  v_add_f32 v118, 1.0, v118
  v_lshlrev_b32 v111, 16, v111
  v_lshlrev_b32 v127, 16, v127
  v_lshlrev_b32 v119, 16, v119
  v_lshlrev_b32 v103, 16, v103
  v_add_f32 v119, 1.0, v119
  v_cvt_pk_bf16_f32 v8, v112, v113
  v_and_b32 v112, 0xffff, v8
  v_and_b32 v113, s70, v8
  v_cvt_pk_bf16_f32 v8, v114, v115
  v_and_b32 v114, 0xffff, v8
  v_and_b32 v115, s70, v8
  v_cvt_pk_bf16_f32 v8, v116, v117
  v_and_b32 v116, 0xffff, v8
  v_and_b32 v117, s70, v8
  v_cvt_pk_bf16_f32 v8, v118, v119
  v_and_b32 v118, 0xffff, v8
  v_and_b32 v119, s70, v8
  s_branch L_setup_done
L_setup_down:
  s_mov_b32 s98, 2
  s_mov_b32 s44, s32
  s_mov_b32 s45, s33
  s_mov_b32 s46, 1409024
  s_mov_b32 s47, 0x20000
  v_lshlrev_b32 v8, 13, v2
  v_lshl_add_u32 v8, v1, 1, v8
  s_mul_i32 s10, s9, 360448
  s_lshl_b32 s11, s99, 5
  s_add_u32 s12, s10, s11
  v_add_u32 v8, s12, v8
  v_add_u32 v9, 0, v8
  buffer_load_ushort v32, v9, s[44:47], 0 offen
  buffer_load_ushort v33, v9, s[44:47], 0 offen offset:1024
  buffer_load_ushort v34, v9, s[44:47], 0 offen offset:2048
  buffer_load_ushort v35, v9, s[44:47], 0 offen offset:3072
  v_add_u32 v9, 4096, v8
  buffer_load_ushort v36, v9, s[44:47], 0 offen
  buffer_load_ushort v37, v9, s[44:47], 0 offen offset:1024
  s_waitcnt vmcnt(5)
  buffer_load_ushort v38, v9, s[44:47], 0 offen offset:2048
  s_waitcnt vmcnt(5)
  buffer_load_ushort v39, v9, s[44:47], 0 offen offset:3072
  v_add_u32 v9, 32768, v8
  s_waitcnt vmcnt(5)
  buffer_load_ushort v40, v9, s[44:47], 0 offen
  s_waitcnt vmcnt(5)
  buffer_load_ushort v41, v9, s[44:47], 0 offen offset:1024
  s_waitcnt vmcnt(5)
  buffer_load_ushort v42, v9, s[44:47], 0 offen offset:2048
  s_waitcnt vmcnt(5)
  buffer_load_ushort v43, v9, s[44:47], 0 offen offset:3072
  v_add_u32 v9, 36864, v8
  s_waitcnt vmcnt(5)
  buffer_load_ushort v44, v9, s[44:47], 0 offen
  s_waitcnt vmcnt(5)
  buffer_load_ushort v45, v9, s[44:47], 0 offen offset:1024
  s_waitcnt vmcnt(5)
  buffer_load_ushort v46, v9, s[44:47], 0 offen offset:2048
  s_waitcnt vmcnt(5)
  buffer_load_ushort v47, v9, s[44:47], 0 offen offset:3072
  v_lshl_or_b32 v64, v33, 16, v32
  v_lshl_or_b32 v65, v35, 16, v34
  v_lshl_or_b32 v66, v37, 16, v36
  v_lshl_or_b32 v67, v39, 16, v38
  v_add_u32 v9, 65536, v8
  s_waitcnt vmcnt(5)
  buffer_load_ushort v48, v9, s[44:47], 0 offen
  s_waitcnt vmcnt(5)
  buffer_load_ushort v49, v9, s[44:47], 0 offen offset:1024
  s_waitcnt vmcnt(5)
  buffer_load_ushort v50, v9, s[44:47], 0 offen offset:2048
  s_waitcnt vmcnt(5)
  buffer_load_ushort v51, v9, s[44:47], 0 offen offset:3072
  v_add_u32 v9, 69632, v8
  s_waitcnt vmcnt(5)
  buffer_load_ushort v52, v9, s[44:47], 0 offen
  s_waitcnt vmcnt(5)
  buffer_load_ushort v53, v9, s[44:47], 0 offen offset:1024
  s_waitcnt vmcnt(5)
  buffer_load_ushort v54, v9, s[44:47], 0 offen offset:2048
  s_waitcnt vmcnt(5)
  buffer_load_ushort v55, v9, s[44:47], 0 offen offset:3072
  v_lshl_or_b32 v68, v41, 16, v40
  v_lshl_or_b32 v69, v43, 16, v42
  v_lshl_or_b32 v70, v45, 16, v44
  v_lshl_or_b32 v71, v47, 16, v46
  v_add_u32 v9, 98304, v8
  s_waitcnt vmcnt(5)
  buffer_load_ushort v56, v9, s[44:47], 0 offen
  s_waitcnt vmcnt(5)
  buffer_load_ushort v57, v9, s[44:47], 0 offen offset:1024
  s_waitcnt vmcnt(5)
  buffer_load_ushort v58, v9, s[44:47], 0 offen offset:2048
  s_waitcnt vmcnt(5)
  buffer_load_ushort v59, v9, s[44:47], 0 offen offset:3072
  v_add_u32 v9, 102400, v8
  s_waitcnt vmcnt(5)
  buffer_load_ushort v60, v9, s[44:47], 0 offen
  s_waitcnt vmcnt(5)
  buffer_load_ushort v61, v9, s[44:47], 0 offen offset:1024
  s_waitcnt vmcnt(5)
  buffer_load_ushort v62, v9, s[44:47], 0 offen offset:2048
  s_waitcnt vmcnt(5)
  buffer_load_ushort v63, v9, s[44:47], 0 offen offset:3072
  v_lshl_or_b32 v72, v49, 16, v48
  v_lshl_or_b32 v73, v51, 16, v50
  v_lshl_or_b32 v74, v53, 16, v52
  v_lshl_or_b32 v75, v55, 16, v54
  v_add_u32 v9, 131072, v8
  s_waitcnt vmcnt(5)
  buffer_load_ushort v32, v9, s[44:47], 0 offen
  s_waitcnt vmcnt(5)
  buffer_load_ushort v33, v9, s[44:47], 0 offen offset:1024
  s_waitcnt vmcnt(5)
  buffer_load_ushort v34, v9, s[44:47], 0 offen offset:2048
  s_waitcnt vmcnt(5)
  buffer_load_ushort v35, v9, s[44:47], 0 offen offset:3072
  v_add_u32 v9, 135168, v8
  s_waitcnt vmcnt(5)
  buffer_load_ushort v36, v9, s[44:47], 0 offen
  s_waitcnt vmcnt(5)
  buffer_load_ushort v37, v9, s[44:47], 0 offen offset:1024
  s_waitcnt vmcnt(5)
  buffer_load_ushort v38, v9, s[44:47], 0 offen offset:2048
  s_waitcnt vmcnt(5)
  buffer_load_ushort v39, v9, s[44:47], 0 offen offset:3072
  v_lshl_or_b32 v76, v57, 16, v56
  v_lshl_or_b32 v77, v59, 16, v58
  v_lshl_or_b32 v78, v61, 16, v60
  v_lshl_or_b32 v79, v63, 16, v62
  v_add_u32 v9, 163840, v8
  s_waitcnt vmcnt(5)
  buffer_load_ushort v40, v9, s[44:47], 0 offen
  s_waitcnt vmcnt(5)
  buffer_load_ushort v41, v9, s[44:47], 0 offen offset:1024
  s_waitcnt vmcnt(5)
  buffer_load_ushort v42, v9, s[44:47], 0 offen offset:2048
  s_waitcnt vmcnt(5)
  buffer_load_ushort v43, v9, s[44:47], 0 offen offset:3072
  v_add_u32 v9, 167936, v8
  s_waitcnt vmcnt(5)
  buffer_load_ushort v44, v9, s[44:47], 0 offen
  s_waitcnt vmcnt(5)
  buffer_load_ushort v45, v9, s[44:47], 0 offen offset:1024
  s_waitcnt vmcnt(5)
  buffer_load_ushort v46, v9, s[44:47], 0 offen offset:2048
  s_waitcnt vmcnt(5)
  buffer_load_ushort v47, v9, s[44:47], 0 offen offset:3072
  v_lshl_or_b32 v80, v33, 16, v32
  v_lshl_or_b32 v81, v35, 16, v34
  v_lshl_or_b32 v82, v37, 16, v36
  v_lshl_or_b32 v83, v39, 16, v38
  v_add_u32 v9, 196608, v8
  s_waitcnt vmcnt(5)
  buffer_load_ushort v48, v9, s[44:47], 0 offen
  s_waitcnt vmcnt(5)
  buffer_load_ushort v49, v9, s[44:47], 0 offen offset:1024
  s_waitcnt vmcnt(5)
  buffer_load_ushort v50, v9, s[44:47], 0 offen offset:2048
  s_waitcnt vmcnt(5)
  buffer_load_ushort v51, v9, s[44:47], 0 offen offset:3072
  v_add_u32 v9, 200704, v8
  s_waitcnt vmcnt(5)
  buffer_load_ushort v52, v9, s[44:47], 0 offen
  s_waitcnt vmcnt(5)
  buffer_load_ushort v53, v9, s[44:47], 0 offen offset:1024
  s_waitcnt vmcnt(5)
  buffer_load_ushort v54, v9, s[44:47], 0 offen offset:2048
  s_waitcnt vmcnt(5)
  buffer_load_ushort v55, v9, s[44:47], 0 offen offset:3072
  v_lshl_or_b32 v84, v41, 16, v40
  v_lshl_or_b32 v85, v43, 16, v42
  v_lshl_or_b32 v86, v45, 16, v44
  v_lshl_or_b32 v87, v47, 16, v46
  v_add_u32 v9, 229376, v8
  s_waitcnt vmcnt(5)
  buffer_load_ushort v56, v9, s[44:47], 0 offen
  s_waitcnt vmcnt(5)
  buffer_load_ushort v57, v9, s[44:47], 0 offen offset:1024
  s_waitcnt vmcnt(5)
  buffer_load_ushort v58, v9, s[44:47], 0 offen offset:2048
  s_waitcnt vmcnt(5)
  buffer_load_ushort v59, v9, s[44:47], 0 offen offset:3072
  v_add_u32 v9, 233472, v8
  s_waitcnt vmcnt(5)
  buffer_load_ushort v60, v9, s[44:47], 0 offen
  s_waitcnt vmcnt(5)
  buffer_load_ushort v61, v9, s[44:47], 0 offen offset:1024
  s_waitcnt vmcnt(5)
  buffer_load_ushort v62, v9, s[44:47], 0 offen offset:2048
  s_waitcnt vmcnt(5)
  buffer_load_ushort v63, v9, s[44:47], 0 offen offset:3072
  v_lshl_or_b32 v88, v49, 16, v48
  v_lshl_or_b32 v89, v51, 16, v50
  v_lshl_or_b32 v90, v53, 16, v52
  v_lshl_or_b32 v91, v55, 16, v54
  v_add_u32 v9, 262144, v8
  s_waitcnt vmcnt(5)
  buffer_load_ushort v32, v9, s[44:47], 0 offen
  s_waitcnt vmcnt(5)
  buffer_load_ushort v33, v9, s[44:47], 0 offen offset:1024
  s_waitcnt vmcnt(5)
  buffer_load_ushort v34, v9, s[44:47], 0 offen offset:2048
  s_waitcnt vmcnt(5)
  buffer_load_ushort v35, v9, s[44:47], 0 offen offset:3072
  v_add_u32 v9, 266240, v8
  s_waitcnt vmcnt(5)
  buffer_load_ushort v36, v9, s[44:47], 0 offen
  s_waitcnt vmcnt(5)
  buffer_load_ushort v37, v9, s[44:47], 0 offen offset:1024
  s_waitcnt vmcnt(5)
  buffer_load_ushort v38, v9, s[44:47], 0 offen offset:2048
  s_waitcnt vmcnt(5)
  buffer_load_ushort v39, v9, s[44:47], 0 offen offset:3072
  v_lshl_or_b32 v92, v57, 16, v56
  v_lshl_or_b32 v93, v59, 16, v58
  v_lshl_or_b32 v94, v61, 16, v60
  v_lshl_or_b32 v95, v63, 16, v62
  v_add_u32 v9, 294912, v8
  s_waitcnt vmcnt(5)
  buffer_load_ushort v40, v9, s[44:47], 0 offen
  s_waitcnt vmcnt(5)
  buffer_load_ushort v41, v9, s[44:47], 0 offen offset:1024
  s_waitcnt vmcnt(5)
  buffer_load_ushort v42, v9, s[44:47], 0 offen offset:2048
  s_waitcnt vmcnt(5)
  buffer_load_ushort v43, v9, s[44:47], 0 offen offset:3072
  v_add_u32 v9, 299008, v8
  s_waitcnt vmcnt(5)
  buffer_load_ushort v44, v9, s[44:47], 0 offen
  s_waitcnt vmcnt(5)
  buffer_load_ushort v45, v9, s[44:47], 0 offen offset:1024
  s_waitcnt vmcnt(5)
  buffer_load_ushort v46, v9, s[44:47], 0 offen offset:2048
  s_waitcnt vmcnt(5)
  buffer_load_ushort v47, v9, s[44:47], 0 offen offset:3072
  v_lshl_or_b32 v96, v33, 16, v32
  v_lshl_or_b32 v97, v35, 16, v34
  v_lshl_or_b32 v98, v37, 16, v36
  v_lshl_or_b32 v99, v39, 16, v38
  v_add_u32 v9, 327680, v8
  s_waitcnt vmcnt(5)
  buffer_load_ushort v48, v9, s[44:47], 0 offen
  s_waitcnt vmcnt(5)
  buffer_load_ushort v49, v9, s[44:47], 0 offen offset:1024
  s_waitcnt vmcnt(5)
  buffer_load_ushort v50, v9, s[44:47], 0 offen offset:2048
  s_waitcnt vmcnt(5)
  buffer_load_ushort v51, v9, s[44:47], 0 offen offset:3072
  v_add_u32 v9, 331776, v8
  s_waitcnt vmcnt(5)
  buffer_load_ushort v52, v9, s[44:47], 0 offen
  s_waitcnt vmcnt(5)
  buffer_load_ushort v53, v9, s[44:47], 0 offen offset:1024
  s_waitcnt vmcnt(5)
  buffer_load_ushort v54, v9, s[44:47], 0 offen offset:2048
  s_waitcnt vmcnt(5)
  buffer_load_ushort v55, v9, s[44:47], 0 offen offset:3072
  v_lshl_or_b32 v100, v41, 16, v40
  v_lshl_or_b32 v101, v43, 16, v42
  v_lshl_or_b32 v102, v45, 16, v44
  v_lshl_or_b32 v103, v47, 16, v46
  s_waitcnt vmcnt(0)
  v_lshl_or_b32 v104, v49, 16, v48
  v_lshl_or_b32 v105, v51, 16, v50
  v_lshl_or_b32 v106, v53, 16, v52
  v_lshl_or_b32 v107, v55, 16, v54
  s_lshl_b32 s10, s99, 4
  v_add_u32 v8, s10, v1
  v_lshlrev_b32 v112, 10, v2
  v_lshl_add_u32 v112, v8, 1, v112
  v_lshrrev_b32 v9, 1, v8
  v_lshlrev_b32 v9, 3, v9
  v_mul_u32_u24 v11, 12288, v2
  v_add_u32 v9, v9, v11
  v_and_b32 v10, 1, v8
  v_lshlrev_b32 v10, 4, v10
  v_and_b32 v111, 0x184, v8
  v_and_b32 v11, 3, v8
  v_lshl_add_u32 v111, v11, 5, v111
  v_bfe_u32 v11, v8, 5, 2
  v_lshl_add_u32 v111, v11, 3, v111
  v_bfe_u32 v11, v8, 4, 1
  v_lshl_add_u32 v111, v11, 1, v111
  v_lshlrev_b32 v111, 1, v111
  v_lshl_add_u32 v111, v2, 10, v111
  v_bfe_u32 v114, v8, 3, 1
  v_lshlrev_b32 v114, 4, v114
  v_lshrrev_b32 v113, 2, v1
  v_lshlrev_b32 v113, 8, v113
  v_lshl_add_u32 v113, v2, 6, v113
  v_and_b32 v11, 3, v0
  v_lshl_add_u32 v113, v11, 4, v113
  s_mul_i32 s14, s9, 2816
  v_add_u32 v113, s14, v113
  s_mov_b32 s14, 92160
L_dp_358:
  buffer_load_dwordx2 v[34:35], v9, s[52:55], s14 offen sc1
  s_waitcnt vmcnt(0)
  v_cmp_ne_u32 vcc, s7, v35
  s_cbranch_vccz L_dpd_359
  s_sleep 16
  s_add_u32 s8, s8, 1
  s_cmp_lt_u32 s8, 262144
  s_cbranch_scc1 L_dp_358
L_dpd_359:
  v_lshrrev_b32 v110, v10, v34
  v_lshlrev_b32 v110, 16, v110
L_setup_done:
  s_getpc_b64 s[10:11]
L_pc2:
  v_lshlrev_b32 v7, 7, v0
  v_min_u32 v7, L_codeend-L_pc2-4, v7
  s_cmp_eq_u32 s9, 0
  s_cbranch_scc0 L_tpf_done
  global_load_dword v7, v7, s[10:11]
  s_waitcnt vmcnt(0)
L_tpf_done:
  v_and_b32 v8, 7, v0
  v_mul_u32_u24 v8, 272, v8
  v_lshl_add_u32 v8, v2, 4, v8
  s_and_b32 s11, s6, 0
  s_lshl_b32 s11, s11, 2
  s_add_u32 s11, s11, s5
  s_lshl_b32 s11, s11, 2
  s_add_u32 s11, s11, s9
  s_mul_i32 s11, s11, 1536
  s_add_u32 s11, s11, 851968
  v_lshlrev_b32 v9, 7, v2
  v_lshl_add_u32 v9, v1, 2, v9
  v_add_u32 v9, s11, v9
  v_mov_b32 v11, s7
  v_mov_b32 v13, 1.0
  s_mov_b32 s60, 0
  s_mov_b32 s61, -1
  s_mov_b32 s18, 0x80008000
  s_mov_b32 s19, 0x80008000
  s_mov_b32 s20, 0x40004000
  s_mov_b32 s21, 0x40004000
  s_mov_b32 s22, 0x20002000
  s_mov_b32 s23, 0x20002000
  s_mov_b32 s24, 0xe000e000
  s_mov_b32 s25, 0xe000e000
  s_add_u32 s56, s42, 69632
  s_addc_u32 s57, s43, 0
  s_mov_b32 s58, 11008
  s_mov_b32 s59, 0x20000
  s_mov_b32 s44, s38
  s_mov_b32 s45, s39
  s_mov_b32 s46, 4096
  s_mov_b32 s47, 0x20000
  s_barrier
  ds_read_b128 v[16:19], v8 offset:512
  ds_read_b128 v[20:23], v8 offset:576
  ds_read_b128 v[24:27], v8 offset:640
  ds_read_b128 v[28:31], v8 offset:704
  s_waitcnt lgkmcnt(3)
  v_mfma_f32_16x16x32_bf16 v[32:35], v[16:19], v[128:131], 0
  s_waitcnt lgkmcnt(2)
  v_mfma_f32_16x16x32_bf16 v[32:35], v[20:23], v[160:163], v[32:35]
  s_waitcnt lgkmcnt(1)
  v_mfma_f32_16x16x32_bf16 v[32:35], v[24:27], v[192:195], v[32:35]
  s_waitcnt lgkmcnt(0)
  v_mfma_f32_16x16x32_bf16 v[32:35], v[28:31], v[224:227], v[32:35]
  v_mfma_f32_16x16x32_bf16 v[36:39], v[16:19], v[132:135], 0
  v_mfma_f32_16x16x32_bf16 v[36:39], v[20:23], v[164:167], v[36:39]
  v_mfma_f32_16x16x32_bf16 v[36:39], v[24:27], v[196:199], v[36:39]
  v_mfma_f32_16x16x32_bf16 v[36:39], v[28:31], v[228:231], v[36:39]
  v_mfma_f32_16x16x32_bf16 v[40:43], v[16:19], v[136:139], 0
  v_mfma_f32_16x16x32_bf16 v[40:43], v[20:23], v[168:171], v[40:43]
  v_mfma_f32_16x16x32_bf16 v[40:43], v[24:27], v[200:203], v[40:43]
  v_mfma_f32_16x16x32_bf16 v[40:43], v[28:31], v[232:235], v[40:43]
  v_add_f32 v32, v32, v33
  v_add_f32 v34, v34, v35
  v_mfma_f32_16x16x32_bf16 v[44:47], v[16:19], v[140:143], 0
  v_add_f32 v32, v32, v34
  v_mfma_f32_16x16x32_bf16 v[44:47], v[20:23], v[172:175], v[44:47]
  v_add_f32 v36, v36, v37
  v_mfma_f32_16x16x32_bf16 v[44:47], v[24:27], v[204:207], v[44:47]
  v_add_f32 v38, v38, v39
  v_mfma_f32_16x16x32_bf16 v[44:47], v[28:31], v[236:239], v[44:47]
  v_add_f32 v36, v36, v38
  v_mfma_f32_16x16x32_bf16 v[48:51], v[16:19], v[144:147], 0
  v_mfma_f32_16x16x32_bf16 v[48:51], v[20:23], v[176:179], v[48:51]
  v_add_f32 v40, v40, v41
  v_mfma_f32_16x16x32_bf16 v[48:51], v[24:27], v[208:211], v[48:51]
  v_add_f32 v42, v42, v43
  v_permlane16_swap_b32 v32, v36
  v_add_f32 v32, v32, v36
  v_mfma_f32_16x16x32_bf16 v[48:51], v[28:31], v[240:243], v[48:51]
  v_add_f32 v40, v40, v42
  v_mfma_f32_16x16x32_bf16 v[52:55], v[16:19], v[148:151], 0
  v_mfma_f32_16x16x32_bf16 v[52:55], v[20:23], v[180:183], v[52:55]
  v_add_f32 v44, v44, v45
  v_mfma_f32_16x16x32_bf16 v[52:55], v[24:27], v[212:215], v[52:55]
  v_add_f32 v46, v46, v47
  v_mfma_f32_16x16x32_bf16 v[52:55], v[28:31], v[244:247], v[52:55]
  v_add_f32 v44, v44, v46
  v_mfma_f32_16x16x32_bf16 v[56:59], v[16:19], v[152:155], 0
  v_mfma_f32_16x16x32_bf16 v[56:59], v[20:23], v[184:187], v[56:59]
  v_add_f32 v48, v48, v49
  v_mfma_f32_16x16x32_bf16 v[56:59], v[24:27], v[216:219], v[56:59]
  v_add_f32 v50, v50, v51
  v_permlane16_swap_b32 v40, v44
  v_add_f32 v40, v40, v44
  v_mfma_f32_16x16x32_bf16 v[56:59], v[28:31], v[248:251], v[56:59]
  v_add_f32 v48, v48, v50
  v_cndmask_b32 v32, v32, v40, s[60:61]
  v_mfma_f32_16x16x32_bf16 v[60:63], v[16:19], v[156:159], 0
  v_cndmask_b32 v33, v32, v13, s[18:19]
  global_atomic_add_f32 v36, v9, v33, s[42:43] sc0
  v_mfma_f32_16x16x32_bf16 v[60:63], v[20:23], v[188:191], v[60:63]
  v_add_f32 v52, v52, v53
  v_mov_b32_dpp v35, v32 row_newbcast:15 row_mask:0xf bank_mask:0xf
  v_mfma_f32_16x16x32_bf16 v[60:63], v[24:27], v[220:223], v[60:63]
  v_add_f32 v54, v54, v55
  v_cndmask_b32 v34, v13, v35, s[22:23]
  v_mfma_f32_16x16x32_bf16 v[60:63], v[28:31], v[252:255], v[60:63]
  v_add_f32 v52, v52, v54
  v_add_f32 v56, v56, v57
  v_add_f32 v58, v58, v59
  v_add_f32 v56, v56, v58
  v_permlane16_swap_b32 v48, v52
  v_add_f32 v48, v48, v52
  s_nop 1
  v_add_f32 v60, v60, v61
  v_add_f32 v62, v62, v63
  v_add_f32 v60, v60, v62
  s_nop 1
  v_permlane16_swap_b32 v56, v60
  v_add_f32 v56, v56, v60
  v_cndmask_b32 v48, v48, v56, s[60:61]
  v_cndmask_b32 v49, v48, v13, s[18:19]
  global_atomic_add_f32 v9, v49, s[42:43] offset:512
  v_mov_b32_dpp v35, v48 row_newbcast:15 row_mask:0xf bank_mask:0xf
  s_mov_b64 exec, s[24:25]
  v_cndmask_b32 v34, v34, v35, s[20:21]
  global_atomic_add_f32 v9, v34, s[42:43] offset:1024
  s_mov_b64 exec, -1
  s_cmp_eq_u32 s98, 0
  s_cbranch_scc1 L_hend
  s_cmp_eq_u32 s98, 2
  s_cbranch_scc1 L_down
  v_mul_u32_u24 v128, 1536, v2
  v_bfe_u32 v10, v0, 2, 2
  v_lshl_add_u32 v128, v10, 7, v128
  v_and_b32 v10, 3, v0
  v_lshl_add_u32 v128, v10, 4, v128
  v_lshlrev_b32 v129, 4, v0
  s_mul_i32 s14, s9, 6144
  s_add_u32 s14, s14, 851968
  s_lshl_b32 s13, s9, 10
  s_add_u32 s13, s13, 917504
  v_mov_b32 v130, 0x3f80
  v_mov_b32 v131, 1.0
  v_mov_b32 v132, 0x3b003b00
  s_mov_b32 s18, 0x88888888
  s_mov_b32 s19, 0x88888888
  s_mov_b32 s20, 0x42800000
  s_mov_b32 s15, 0x3b000000
  s_mul_i32 s10, s9, 1040
  v_lshlrev_b32 v8, 4, v0
  v_add_u32 v8, s10, v8
  v_and_b32 v10, 3, v0
  v_mul_u32_u24 v10, 1040, v10
  v_lshl_add_u32 v10, v2, 4, v10
  s_lshl_b32 s10, s9, 8
  v_add_u32 v10, s10, v10
  s_waitcnt vmcnt(2)
  v_cvt_u32_f32 v36, v36
  s_nop 0
  v_readlane_b32 s10, v36, 15
  s_sub_i32 s10, 63, s10
  s_mul_i32 s10, s10, 2
  s_ashr_i32 s10, s10, 2
  s_add_i32 s10, s10, 17
  s_min_i32 s10, s10, 80
L_bk_362:
  s_sub_i32 s10, s10, 1
  s_cmp_lt_i32 s10, 0
  s_cbranch_scc1 L_fp_360
  s_sleep 1
  s_branch L_bk_362
L_fp_360:
  buffer_load_dwordx4 v[32:35], v128, s[52:55], s14 offen sc1
  buffer_load_dwordx4 v[36:39], v128, s[52:55], s14 offen offset:512 sc1
  buffer_load_dwordx4 v[40:43], v128, s[52:55], s14 offen offset:1024 sc1
  s_waitcnt vmcnt(0)
  v_min3_f32 v40, v35, v39, v43
  v_cndmask_b32 v35, v35, v41, s[18:19]
  v_cmp_neq_f32 vcc, s20, v40
  v_cndmask_b32 v39, v39, v42, s[18:19]
  s_and_b64 s[10:11], vcc, s[18:19]
  s_cbranch_scc0 L_fpd_361
  v_cvt_u32_f32 v40, v40
  s_nop 0
  v_readlane_b32 s10, v40, 3
  s_sub_i32 s10, 62, s10
  s_min_i32 s10, s10, 40
  s_add_u32 s8, s8, 1
  s_cmp_lt_u32 s8, 262144
  s_cbranch_scc1 L_bk_362
L_fpd_361:
  v_cvt_pk_bf16_f32 v16, v32, v33
  v_cvt_pk_bf16_f32 v17, v34, v35
  v_cvt_pk_bf16_f32 v18, v36, v37
  v_cvt_pk_bf16_f32 v19, v38, v39
  v_dot2_f32_bf16 v32, v16, v104, 0
  v_dot2_f32_bf16 v33, v16, v105, 0
  v_dot2_f32_bf16 v34, v17, v106, 0
  v_dot2_f32_bf16 v35, v17, v107, 0
  v_dot2_f32_bf16 v36, v18, v108, 0
  v_dot2_f32_bf16 v37, v18, v109, 0
  v_dot2_f32_bf16 v38, v19, v110, 0
  v_dot2_f32_bf16 v39, v19, v111, 0
  v_cvt_pk_bf16_f32 v16, v32, v33
  v_cvt_pk_bf16_f32 v17, v34, v35
  v_cvt_pk_bf16_f32 v18, v36, v37
  v_cvt_pk_bf16_f32 v19, v38, v39
  s_cmp_eq_u32 s99, 86
  v_dot2_f32_bf16 v32, v16, v130, v96
  v_dot2_f32_bf16 v33, v16, v131, v97
  v_dot2_f32_bf16 v34, v17, v130, v98
  v_dot2_f32_bf16 v35, v17, v131, v99
  v_dot2_f32_bf16 v36, v18, v130, v100
  v_dot2_f32_bf16 v37, v18, v131, v101
  v_dot2_f32_bf16 v38, v19, v130, v102
  v_dot2_f32_bf16 v39, v19, v131, v103
  v_cvt_pk_bf16_f32 v20, v32, v33
  v_cvt_pk_bf16_f32 v21, v34, v35
  v_cvt_pk_bf16_f32 v22, v36, v37
  v_cvt_pk_bf16_f32 v23, v38, v39
  v_dot2_f32_bf16 v24, v20, v132, 0
  v_dot2_f32_bf16 v25, v20, v20, 0
  v_dot2_f32_bf16 v24, v21, v132, v24
  v_dot2_f32_bf16 v25, v21, v21, v25
  v_dot2_f32_bf16 v24, v22, v132, v24
  v_dot2_f32_bf16 v25, v22, v22, v25
  v_dot2_f32_bf16 v24, v23, v132, v24
  v_dot2_f32_bf16 v25, v23, v23, v25
  s_nop 1
  v_add_f32_dpp v24, v24, v24 row_ror:8 row_mask:0xf bank_mask:0xf
  v_add_f32_dpp v25, v25, v25 row_ror:8 row_mask:0xf bank_mask:0xf
  s_nop 0
  v_add_f32_dpp v24, v24, v24 row_ror:4 row_mask:0xf bank_mask:0xf
  v_add_f32_dpp v25, v25, v25 row_ror:4 row_mask:0xf bank_mask:0xf
  s_nop 0
  v_add_f32_dpp v24, v24, v24 row_ror:2 row_mask:0xf bank_mask:0xf
  v_add_f32_dpp v25, v25, v25 row_ror:2 row_mask:0xf bank_mask:0xf
  s_nop 0
  v_add_f32_dpp v24, v24, v24 row_ror:1 row_mask:0xf bank_mask:0xf
  v_add_f32_dpp v25, v25, v25 row_ror:1 row_mask:0xf bank_mask:0xf
  s_nop 0
  v_add_f32_dpp v24, v24, v24 row_bcast:15 row_mask:0xa bank_mask:0xf
  v_add_f32_dpp v25, v25, v25 row_bcast:15 row_mask:0xa bank_mask:0xf
  s_nop 0
  v_add_f32_dpp v24, v24, v24 row_bcast:31 row_mask:0xc bank_mask:0xf
  v_add_f32_dpp v25, v25, v25 row_bcast:31 row_mask:0xc bank_mask:0xf
  v_mul_f32 v26, v24, v24
  v_fma_f32 v25, v25, s15, -v26
  v_max_f32 v25, 0, v25
  v_cvt_pk_bf16_f32 v26, v24, v25
  v_lshlrev_b32 v24, 16, v26
  v_and_b32 v25, s70, v26
  v_readlane_b32 s12, v24, 63
  v_add_f32 v25, 0x3727c5ac, v25
  v_cvt_pk_bf16_f32 v25, v25, v25
  v_dot2_f32_bf16 v32, v20, v130, s12 neg_lo:[0,0,1]
  v_and_b32 v25, s70, v25
  v_dot2_f32_bf16 v33, v20, v131, s12 neg_lo:[0,0,1]
  v_sqrt_f32 v25, v25
  v_dot2_f32_bf16 v34, v21, v130, s12 neg_lo:[0,0,1]
  v_dot2_f32_bf16 v35, v21, v131, s12 neg_lo:[0,0,1]
  v_cvt_pk_bf16_f32 v25, v25, v25
  v_dot2_f32_bf16 v36, v22, v130, s12 neg_lo:[0,0,1]
  v_and_b32 v25, s70, v25
  v_dot2_f32_bf16 v37, v22, v131, s12 neg_lo:[0,0,1]
  v_rcp_f32 v25, v25
  v_dot2_f32_bf16 v38, v23, v130, s12 neg_lo:[0,0,1]
  v_dot2_f32_bf16 v39, v23, v131, s12 neg_lo:[0,0,1]
  v_readlane_b32 s10, v25, 63
  v_cvt_pk_bf16_f32 v16, v32, v33
  v_cvt_pk_bf16_f32 v17, v34, v35
  v_cvt_pk_bf16_f32 v18, v36, v37
  v_cvt_pk_bf16_f32 v19, v38, v39
  v_lshlrev_b32 v32, 16, v16
  v_and_b32 v33, s70, v16
  v_lshlrev_b32 v34, 16, v17
  v_and_b32 v35, s70, v17
  v_lshlrev_b32 v36, 16, v18
  v_and_b32 v37, s70, v18
  v_lshlrev_b32 v38, 16, v19
  v_and_b32 v39, s70, v19
  v_pk_mul_f32 v[32:33], v[32:33], s[10:11] op_sel_hi:[1,0]
  v_pk_mul_f32 v[34:35], v[34:35], s[10:11] op_sel_hi:[1,0]
  v_pk_mul_f32 v[36:37], v[36:37], s[10:11] op_sel_hi:[1,0]
  v_pk_mul_f32 v[38:39], v[38:39], s[10:11] op_sel_hi:[1,0]
  v_cvt_pk_bf16_f32 v16, v32, v33
  v_cvt_pk_bf16_f32 v17, v34, v35
  v_cvt_pk_bf16_f32 v18, v36, v37
  v_cvt_pk_bf16_f32 v19, v38, v39
  v_dot2_f32_bf16 v32, v16, v112, 0
  v_dot2_f32_bf16 v33, v16, v113, 0
  v_dot2_f32_bf16 v34, v17, v114, 0
  v_dot2_f32_bf16 v35, v17, v115, 0
  v_dot2_f32_bf16 v36, v18, v116, 0
  v_dot2_f32_bf16 v37, v18, v117, 0
  v_dot2_f32_bf16 v38, v19, v118, 0
  v_dot2_f32_bf16 v39, v19, v119, 0
  v_cvt_pk_bf16_f32 v16, v32, v33
  v_cvt_pk_bf16_f32 v17, v34, v35
  v_cvt_pk_bf16_f32 v18, v36, v37
  v_cvt_pk_bf16_f32 v19, v38, v39
  v_dot2_f32_bf16 v32, v16, v130, v120
  v_dot2_f32_bf16 v33, v16, v131, v121
  v_dot2_f32_bf16 v34, v17, v130, v122
  v_dot2_f32_bf16 v35, v17, v131, v123
  v_dot2_f32_bf16 v36, v18, v130, v124
  v_dot2_f32_bf16 v37, v18, v131, v125
  v_dot2_f32_bf16 v38, v19, v130, v126
  v_dot2_f32_bf16 v39, v19, v131, v127
  v_cvt_pk_bf16_f32 v16, v32, v33
  v_cvt_pk_bf16_f32 v17, v34, v35
  v_cvt_pk_bf16_f32 v18, v36, v37
  v_cvt_pk_bf16_f32 v19, v38, v39
  ds_write_b128 v8, v[16:19] offset:11264
  s_cbranch_scc1 L_x1pub
  s_waitcnt lgkmcnt(0)
  s_barrier
  ds_read_b128 v[16:19], v10 offset:11264
  ds_read_b128 v[20:23], v10 offset:11328
  ds_read_b128 v[24:27], v10 offset:11392
  ds_read_b128 v[28:31], v10 offset:11456
  s_lshl_b32 s10, s9, 9
  v_lshlrev_b32 v8, 4, v1
  v_add_u32 v8, s10, v8
  s_waitcnt lgkmcnt(3)
  v_mfma_f32_16x16x32_bf16 v[32:35], v[16:19], v[64:67], 0
  v_mfma_f32_16x16x32_bf16 v[36:39], v[16:19], v[68:71], 0
  s_waitcnt lgkmcnt(2)
  v_mfma_f32_16x16x32_bf16 v[32:35], v[20:23], v[72:75], v[32:35]
  v_mfma_f32_16x16x32_bf16 v[36:39], v[20:23], v[76:79], v[36:39]
  s_waitcnt lgkmcnt(1)
  v_mfma_f32_16x16x32_bf16 v[32:35], v[24:27], v[80:83], v[32:35]
  v_mfma_f32_16x16x32_bf16 v[36:39], v[24:27], v[84:87], v[36:39]
  s_waitcnt lgkmcnt(0)
  v_mfma_f32_16x16x32_bf16 v[32:35], v[28:31], v[88:91], v[32:35]
  v_mfma_f32_16x16x32_bf16 v[36:39], v[28:31], v[92:95], v[36:39]
  v_and_b32 v10, 1, v0
  v_lshlrev_b32 v10, 8, v10
  v_lshrrev_b32 v9, 1, v1
  v_lshl_add_u32 v10, v9, 4, v10
  v_lshl_add_u32 v10, v2, 2, v10
  v_add_u32 v10, 7168, v10
  s_mov_b64 exec, 0xffff
  s_nop 0
  ds_write_b128 v8, v[32:35] offset:7168
  ds_write_b128 v8, v[36:39] offset:7424
  s_mov_b64 exec, -1
  s_waitcnt lgkmcnt(0)
  s_barrier
  s_cmp_eq_u32 s9, 0
  s_cbranch_scc0 L_hend
  v_add_u32 v8, 1024, v10
  ds_read2_b32 v[32:33], v10 offset0:0 offset1:32
  ds_read2_b32 v[34:35], v10 offset0:128 offset1:160
  ds_read2_b32 v[36:37], v8 offset0:0 offset1:32
  ds_read2_b32 v[38:39], v8 offset0:128 offset1:160
  v_bfe_u32 v9, v0, 3, 1
  v_lshlrev_b32 v9, 6, v9
  v_lshl_add_u32 v9, v2, 4, v9
  v_and_b32 v11, 7, v0
  v_lshl_add_u32 v9, v11, 1, v9
  s_lshl_b32 s12, s99, 7
  s_waitcnt lgkmcnt(0)
  v_add_f32 v32, v32, v34
  v_add_f32 v36, v36, v38
  v_add_f32 v33, v33, v35
  v_add_f32 v37, v37, v39
  v_add_f32 v32, v32, v36
  v_add_f32 v33, v33, v37
  v_cvt_pk_bf16_f32 v34, v32, v33
  v_lshlrev_b32 v32, 16, v34
  v_and_b32 v33, s70, v34
  v_mul_f32 v34, v32, v32
  v_mul_f32 v34, v34, v32
  v_mul_f32 v34, 0x3d372713, v34
  v_add_f32 v34, v34, v32
  v_mul_f32 v34, 0xc0135761, v34
  v_exp_f32 v34, v34
  s_nop 0
  v_add_f32 v34, 1.0, v34
  v_rcp_f32 v34, v34
  s_nop 0
  v_mul_f32 v34, v34, v32
  v_cvt_pk_bf16_f32 v34, v34, v34
  v_and_b32 v34, s70, v34
  v_mul_f32 v34, v34, v33
  s_nop 1
  v_mov_b32_dpp v32, v34 quad_perm:[1,1,3,3] row_mask:0xf bank_mask:0xf
  v_cvt_pk_bf16_f32 v34, v34, v32
  v_min_u32 v34, -2, v34
  s_mov_b32 exec_lo, 0x55555555
  s_mov_b32 exec_hi, 0x55555555
  buffer_store_dword v34, v9, s[56:59], s12 offen sc1
  s_mov_b64 exec, -1
  s_branch L_hend
L_x1pub:
  v_min_u32 v44, -2, v20
  v_min_u32 v45, -2, v21
  v_min_u32 v46, -2, v22
  v_min_u32 v47, -2, v23
  buffer_store_dwordx4 v[44:47], v129, s[52:55], s13 offen sc1
  s_branch L_hend
L_down:
  s_mov_b32 s12, 917504
  s_lshl_b32 s10, s9, 8
  v_lshlrev_b32 v9, 2, v0
  v_add_u32 v8, s10, v9
L_xp_363:
  buffer_load_dword v108, v111, s[52:55], s12 offen sc1
  s_waitcnt vmcnt(0)
  v_cmp_eq_u32 vcc, -1, v108
  s_cbranch_vccz L_xpd_364
  s_add_u32 s8, s8, 1
  s_cmp_lt_u32 s8, 262144
  s_cbranch_scc1 L_xp_363
L_xpd_364:
L_hp_365:
  buffer_load_dwordx4 v[16:19], v113, s[56:59], 0 offen sc1
  buffer_load_dwordx4 v[20:23], v113, s[56:59], 0 offen offset:1024 sc1
  buffer_load_dwordx4 v[24:27], v113, s[56:59], 0 offen offset:2048 sc1
  s_waitcnt vmcnt(0)
  v_max3_u32 v32, v16, v17, v18
  v_max3_u32 v33, v19, v20, v21
  v_max3_u32 v32, v32, v22, v23
  v_max3_u32 v33, v33, v24, v25
  v_max3_u32 v32, v32, v26, v27
  v_max_u32 v32, v32, v33
  v_cmp_eq_u32 vcc, -1, v32
  s_cbranch_vccz L_hpd_366
  s_add_u32 s8, s8, 1
  s_cmp_lt_u32 s8, 262144
  s_cbranch_scc1 L_hp_365
L_hpd_366:
  v_mfma_f32_16x16x32_bf16 v[32:35], v[16:19], v[64:67], 0
  v_mfma_f32_16x16x32_bf16 v[36:39], v[16:19], v[68:71], 0
  v_mfma_f32_16x16x32_bf16 v[40:43], v[16:19], v[72:75], 0
  v_mfma_f32_16x16x32_bf16 v[44:47], v[16:19], v[76:79], 0
  v_mfma_f32_16x16x32_bf16 v[32:35], v[20:23], v[80:83], v[32:35]
  v_mfma_f32_16x16x32_bf16 v[36:39], v[20:23], v[84:87], v[36:39]
  v_mfma_f32_16x16x32_bf16 v[40:43], v[20:23], v[88:91], v[40:43]
  v_mfma_f32_16x16x32_bf16 v[44:47], v[20:23], v[92:95], v[44:47]
  v_mfma_f32_16x16x32_bf16 v[32:35], v[24:27], v[96:99], v[32:35]
  v_mfma_f32_16x16x32_bf16 v[36:39], v[24:27], v[100:103], v[36:39]
  v_mfma_f32_16x16x32_bf16 v[40:43], v[24:27], v[104:107], v[40:43]
  v_lshrrev_b32 v108, v114, v108
  v_lshlrev_b32 v108, 16, v108
  s_nop 5
  v_mov_b32_dpp v32, v44 quad_perm:[0,1,2,3] row_mask:0x8 bank_mask:0xf
  v_mov_b32_dpp v33, v45 quad_perm:[0,1,2,3] row_mask:0x8 bank_mask:0xf
  v_mov_b32_dpp v34, v46 quad_perm:[0,1,2,3] row_mask:0x8 bank_mask:0xf
  v_mov_b32_dpp v35, v47 quad_perm:[0,1,2,3] row_mask:0x8 bank_mask:0xf
  v_mov_b32_dpp v32, v36 quad_perm:[0,1,2,3] row_mask:0x2 bank_mask:0xf
  v_mov_b32_dpp v33, v37 quad_perm:[0,1,2,3] row_mask:0x2 bank_mask:0xf
  v_mov_b32_dpp v34, v38 quad_perm:[0,1,2,3] row_mask:0x2 bank_mask:0xf
  v_mov_b32_dpp v35, v39 quad_perm:[0,1,2,3] row_mask:0x2 bank_mask:0xf
  v_mov_b32_dpp v32, v40 quad_perm:[0,1,2,3] row_mask:0x4 bank_mask:0xf
  v_mov_b32_dpp v33, v41 quad_perm:[0,1,2,3] row_mask:0x4 bank_mask:0xf
  v_mov_b32_dpp v34, v42 quad_perm:[0,1,2,3] row_mask:0x4 bank_mask:0xf
  v_mov_b32_dpp v35, v43 quad_perm:[0,1,2,3] row_mask:0x4 bank_mask:0xf
  s_nop 0
  v_permlane16_swap_b32 v32, v33
  v_permlane16_swap_b32 v34, v35
  v_add_f32 v32, v32, v33
  v_add_f32 v34, v34, v35
  s_nop 1
  v_permlane32_swap_b32 v32, v34
  v_add_f32 v32, v32, v34
  ds_write_b32 v8, v32 offset:15616
  s_waitcnt lgkmcnt(0)
  s_barrier
  s_cmp_eq_u32 s9, 0
  s_cbranch_scc0 L_hend
  ds_read2st64_b32 v[34:35], v9 offset0:62 offset1:63
  ds_read_b32 v33, v9 offset:16384
  s_waitcnt lgkmcnt(0)
  v_add_f32 v32, v32, v33
  v_add_f32 v34, v34, v35
  v_add_f32 v32, v32, v34
  v_cvt_pk_bf16_f32 v32, v32, v32
  v_and_b32 v32, s70, v32
  v_mul_f32 v32, v32, v110
  v_cvt_pk_bf16_f32 v32, v32, v32
  v_and_b32 v32, s70, v32
  v_add_f32 v32, v32, v108
  v_cvt_pk_bf16_f32 v32, v32, v32
  buffer_store_short v32, v112, s[44:47], 0 offen
  s_cmp_eq_u32 s99, 0
  s_cbranch_scc0 L_hend
  s_mov_b64 exec, 1
  buffer_store_dword v11, v3, s[52:55], 0 offen sc1
  s_mov_b64 exec, -1
L_hend:
L_end:
  s_endpgm
L_codeend:
.section .rodata,"a"
.p2align 6
.amdhsa_kernel adaLN_cond__gqa_block_cached__glu_gated_geglu__decode_kernel
  .amdhsa_next_free_vgpr 256
  .amdhsa_next_free_sgpr 102
  .amdhsa_accum_offset 256
  .amdhsa_group_segment_fixed_size 0
  .amdhsa_kernarg_size 112
  .amdhsa_user_sgpr_count 2
  .amdhsa_user_sgpr_kernarg_segment_ptr 1
  .amdhsa_system_sgpr_workgroup_id_x 1
.end_amdhsa_kernel
```
